```python
import torch

def _softmax(x, axis=-1):
    return torch.softmax(x, dim=axis)
def _gelu(x):
    return torch.nn.functional.gelu(x, approximate="tanh")
def _silu(x):
    return torch.nn.functional.silu(x)
def _sigmoid(x):
    return torch.sigmoid(x)
def _layernorm(x, axis=-1, eps=1e-5):
    m = x.mean(dim=axis, keepdim=True)
    v = x.var(dim=axis, keepdim=True, unbiased=False)
    return (x - m) / torch.sqrt(v + eps)
def _scatter_add(tgt, idx, src, axis=0):
    return tgt.clone().index_add_(axis, idx, src)
def _segment_sum(src, seg, n):
    out = torch.zeros((n,) + src.shape[1:], dtype=src.dtype)
    return out.index_add_(0, seg, src)
def _pad(x, pw):
    flat = tuple(v for pair in reversed(pw) for v in pair)
    return torch.nn.functional.pad(x, flat)

kernel_name = 'standalone__geglu_ffn__sampling'

def setup_inputs():

    _w = (lambda a: (lambda t: t.to(torch.bfloat16) if t.is_floating_point() else t)(torch.as_tensor(a)))
    B, S, D, F = 32, 32, 1024, 3584
    return {
        "x": _w((lambda *s: torch.randn(*s, dtype=torch.bfloat16) * 0.05)(B, S, D)),
        "w_gate": _w((lambda *s: torch.randn(*s, dtype=torch.bfloat16) * 0.05)(D, F)),
        "w_up": _w((lambda *s: torch.randn(*s, dtype=torch.bfloat16) * 0.05)(D, F)),
        "w_down": _w((lambda *s: torch.randn(*s, dtype=torch.bfloat16) * 0.05)(F, D)),
    }

def reference(x, w_gate, w_up, w_down):
    return (_gelu(x @ w_gate) * (x @ w_up)) @ w_down
```

```asm
; @launch grid=(256,1,1) block=(512,1,1) lds=163840
.amdgcn_target "amdgcn-amd-amdhsa--gfx950"
.text
.globl standalone__geglu_ffn__sampling_kernel
.p2align 8
.type standalone__geglu_ffn__sampling_kernel,@function
standalone__geglu_ffn__sampling_kernel:

s_cmp_ge_u32 s2, 256
s_cbranch_scc1 L_end
s_load_dwordx8 s[36:43], s[0:1], 0
s_load_dwordx4 s[44:47], s[0:1], 32
s_load_dwordx2 s[48:49], s[0:1], 48
v_lshrrev_b32 v1, 6, v0
v_and_b32 v0, 63, v0
s_and_b32 s29, s2, 7
s_lshr_b32 s30, s2, 3
v_readfirstlane_b32 s28, v1
s_lshr_b32 s25, s29, 1
s_and_b32 s33, s29, 1
s_cmp_ge_u32 s30, 14
s_cselect_b32 s99, 14, 0
s_addc_u32 s31, s33, s33
s_sub_u32 s99, s30, s99
s_mul_i32 s32, s25, 14
s_add_u32 s32, s32, s99
s_cmp_lt_u32 s28, 4
s_cbranch_scc1 L_comp
s_sub_u32 s33, s28, 4
v_lshrrev_b32 v1, 3, v0
v_and_b32 v2, 7, v0
v_lshrrev_b32 v3, 4, v0
v_lshl_add_u32 v31, s33, 4, v1
v_mul_u32_u24 v31, 7168, v31
v_and_b32 v27, 2, v1
v_lshl_add_u32 v31, s32, 7, v31
v_xor_b32 v29, v2, v27
v_lshl_add_u32 v13, v29, 4, v31
v_xor_b32 v14, 64, v13
v_add_u32 v14, 56320, v14
s_lshl_b32 s55, s33, 11
s_and_b32 s20, s31, 1
s_mul_i32 s20, s20, 2
s_add_u32 s20, s20, s99
s_mul_i32 s21, s29, 4
s_and_b32 s56, s20, 3
s_and_b32 s57, s21, 12
s_or_b32 s56, s56, s57
s_mul_i32 s57, s56, 458752
s_mov_b32 s10, 7340032
s_mov_b32 s11, 0x20000
s_mov_b64 s[14:15], s[10:11]
s_cmp_ge_u32 s30, 28
s_waitcnt lgkmcnt(0)
s_cbranch_scc1 L_lidle
s_mov_b64 s[8:9], s[38:39]
s_mov_b64 s[12:13], s[40:41]
s_add_u32 m0, s55, 0
s_nop 0
buffer_load_dwordx4 v13, s[8:11], s57 offen lds
buffer_load_dwordx4 v14, s[8:11], s57 offen offset:1024 lds
s_add_u32 m0, s55, 8192
s_nop 0
buffer_load_dwordx4 v13, s[12:15], s57 offen lds
buffer_load_dwordx4 v14, s[12:15], s57 offen offset:1024 lds
s_mul_i32 s54, s33, 24576
s_add_u32 s54, s54, 49152
v_lshlrev_b32 v28, 11, v1
s_sub_u32 s4, s36, 4096
s_subb_u32 s5, s37, 0
s_mov_b32 s6, 2101248
s_mov_b32 s7, s11
s_lshl_b32 s56, s56, 7
s_lshl_b32 s34, s31, 2
s_add_u32 s34, s34, s33
v_lshl_add_u32 v31, s34, 17, v28
v_xor_b32 v29, v2, v3
v_lshl_add_u32 v29, v29, 4, v31
v_xor_b32 v30, 64, v29
v_add_u32 v4, 4096, v29
v_add_u32 v5, 19456, v30
v_add_u32 v6, 2048, v29
v_add_u32 v7, 17408, v30
s_lshl_b32 s52, s25, 15
s_add_u32 s53, s52, 131072
s_and_b32 s53, s53, 0x1c000
v_add_u32 v10, s53, v6
v_add_u32 v11, s53, v7
s_add_u32 s53, s52, 98304
s_and_b32 s53, s53, 0x1c000
v_add_u32 v8, s53, v4
v_add_u32 v9, s53, v5
s_add_u32 s53, s52, 65536
s_and_b32 s53, s53, 0x1c000
v_add_u32 v6, s53, v6
v_add_u32 v7, s53, v7
s_add_u32 s53, s52, 32768
s_and_b32 s53, s53, 0x1c000
v_add_u32 v4, s53, v4
v_add_u32 v5, s53, v5
s_add_u32 m0, s54, 0
s_nop 0
buffer_load_dwordx4 v4, s[4:7], s56 offen offset:0 lds
buffer_load_dwordx4 v5, s[4:7], s56 offen offset:1024 lds
buffer_load_dwordx4 v6, s[4:7], s56 offen offset:2048 lds
buffer_load_dwordx4 v7, s[4:7], s56 offen offset:3072 lds
s_add_u32 m0, s54, 4096
s_nop 0
buffer_load_dwordx4 v8, s[4:7], s56 offen offset:0 lds
buffer_load_dwordx4 v9, s[4:7], s56 offen offset:1024 lds
buffer_load_dwordx4 v10, s[4:7], s56 offen offset:2048 lds
buffer_load_dwordx4 v11, s[4:7], s56 offen offset:3072 lds
s_mov_b32 s22, 1985491476
s_mov_b32 s23, 267238044
s_mul_i32 s35, s30, 86
s_lshr_b32 s35, s35, 8
s_mul_i32 s35, s35, 3
s_sub_u32 s35, s30, s35
s_cmp_eq_u32 s35, 1
s_cselect_b32 s22, 1988440641, s22
s_cselect_b32 s23, 267238089, s23
s_cmp_eq_u32 s35, 2
s_cselect_b32 s22, 2019898401, s22
s_cselect_b32 s23, 267238569, s23
s_add_u32 s56, s22, s20
s_and_b32 s56, s56, 3
s_add_u32 s57, s22, s21
s_and_b32 s57, s57, 12
s_or_b32 s56, s56, s57
s_lshr_b64 s[22:23], s[22:23], 4
s_mul_i32 s57, s56, 458752
s_lshl_b32 s56, s56, 7
s_add_u32 m0, s55, 16384
s_nop 0
buffer_load_dwordx4 v13, s[8:11], s57 offen lds
buffer_load_dwordx4 v14, s[8:11], s57 offen offset:1024 lds
s_add_u32 m0, s55, 24576
s_nop 0
buffer_load_dwordx4 v13, s[12:15], s57 offen lds
buffer_load_dwordx4 v14, s[12:15], s57 offen offset:1024 lds
s_add_u32 m0, s54, 8192
s_nop 0
buffer_load_dwordx4 v4, s[4:7], s56 offen offset:0 lds
buffer_load_dwordx4 v5, s[4:7], s56 offen offset:1024 lds
buffer_load_dwordx4 v6, s[4:7], s56 offen offset:2048 lds
buffer_load_dwordx4 v7, s[4:7], s56 offen offset:3072 lds
s_add_u32 m0, s54, 12288
s_nop 0
buffer_load_dwordx4 v8, s[4:7], s56 offen offset:0 lds
buffer_load_dwordx4 v9, s[4:7], s56 offen offset:1024 lds
buffer_load_dwordx4 v10, s[4:7], s56 offen offset:2048 lds
buffer_load_dwordx4 v11, s[4:7], s56 offen offset:3072 lds
s_add_u32 s56, s22, s20
s_and_b32 s56, s56, 3
s_add_u32 s57, s22, s21
s_and_b32 s57, s57, 12
s_or_b32 s56, s56, s57
s_lshr_b64 s[22:23], s[22:23], 4
s_mul_i32 s57, s56, 458752
s_lshl_b32 s56, s56, 7
s_lshr_b32 s24, s30, 3
s_and_b32 s35, s29, 1
s_lshl_b32 s35, s35, 2
s_add_u32 s24, s24, s35
s_and_b32 s27, s30, 7
s_xor_b32 s27, s27, s35
s_lshl_b32 s26, s24, 3
s_add_u32 s26, s26, s27
s_lshl_b32 s26, s26, 2
s_lshl_b32 s97, s24, 2
s_add_u32 s97, s97, s25
s_lshl_b32 s97, s97, 7
s_add_u32 s97, s97, 25165824
s_mul_i32 s100, s24, 917504
s_mul_i32 s35, s25, 28672
s_add_u32 s100, s100, s35
s_mov_b32 s16, s48
s_and_b32 s17, s49, 0xffff
s_mov_b32 s18, 268435456
s_mov_b32 s19, 0x20000
v_lshlrev_b32 v12, 4, v0
v_lshlrev_b32 v29, 1, v3
v_xor_b32 v29, v29, v2
v_lshl_add_u32 v29, v29, 4, v28
v_add_u32 v16, 0, v29
v_add_u32 v17, 15360, v29
v_add_u32 v18, 30720, v29
v_add_u32 v19, 46080, v29
s_mul_i32 s58, s25, 896
s_lshr_b32 s35, s33, 1
s_mul_i32 s59, s35, 448
s_add_u32 s58, s58, s59
s_lshl_b32 s58, s58, 11
s_lshl_b32 s59, s27, 8
s_add_u32 s58, s58, s59
s_and_b32 s59, s33, 1
s_lshl_b32 s53, s59, 7
s_add_u32 s58, s58, s53
v_lshrrev_b32 v29, 2, v0
v_and_b32 v30, 3, v0
v_lshlrev_b32 v30, 3, v30
v_lshl_add_u32 v30, v29, 7, v30
v_and_b32 v29, 3, v1
s_and_b32 s53, s33, 2
v_xor_b32 v29, s53, v29
v_lshl_add_u32 v20, v29, 5, v30
v_xor_b32 v21, 32, v20
s_lshl_b32 s59, s33, 12
s_xor_b32 s45, s59, 0x2000
s_mul_i32 s44, s45, 6
s_add_u32 s44, s44, 49152
s_and_b32 s53, s33, 1
s_mul_i32 s53, s53, 15360
s_lshl_b32 s52, s35, 6
s_add_u32 s53, s53, s52
s_add_u32 s53, s53, 147456
v_mov_b32 v22, s53
v_xor_b32 v23, 64, v22
s_mul_i32 s53, s35, 49152
s_add_u32 s52, s53, 49152
v_add_u32 v0, s52, v12
s_sub_u32 s52, 98304, s53
v_add_u32 v1, s52, v12
s_mul_i32 s53, s35, 99328
s_add_u32 s39, s53, -49152
s_sub_u32 s40, 50176, s53
s_lshl_b32 s41, s33, 11
s_add_u32 s41, s41, 32768
s_sub_u32 s41, s41, s52
s_lshl_b32 s53, s33, 10
s_sub_u32 s53, s53, s52
s_add_u32 s36, s25, 1
s_and_b32 s36, s36, 3
s_add_u32 s36, s36, s26
s_lshl_b32 s92, s36, 2
s_add_u32 s92, s92, s33
s_lshl_b32 s92, s92, 7
s_add_u32 s92, s92, 25231360
s_mul_i32 s36, s36, 24576
s_add_u32 s36, s36, s53
s_add_u32 s36, s36, 8388608
s_add_u32 s37, s25, 2
s_and_b32 s37, s37, 3
s_add_u32 s37, s37, s26
s_mul_i32 s37, s37, 24576
s_add_u32 s37, s37, s53
s_add_u32 s37, s37, 8396800
s_add_u32 s38, s25, 3
s_and_b32 s38, s38, 3
s_add_u32 s38, s38, s26
s_mul_i32 s38, s38, 24576
s_add_u32 s38, s38, s53
s_add_u32 s38, s38, 8404992
s_mov_b32 s51, 32768
s_mov_b32 s24, s42
s_and_b32 s25, s43, 0xffff
s_mov_b32 s26, 7340032
s_mov_b32 s27, 0x20000
s_add_u32 s53, s59, 147456
s_add_u32 s52, s45, 147456
v_add_u32 v24, s53, v20
v_add_u32 v26, s52, v20
v_add_u32 v25, s53, v21
v_add_u32 v27, s52, v21
s_waitcnt vmcnt(12)
s_barrier
s_add_u32 m0, s55, 32768
s_nop 0
buffer_load_dwordx4 v13, s[8:11], s57 offen lds
buffer_load_dwordx4 v14, s[8:11], s57 offen offset:1024 lds
s_add_u32 m0, s55, 40960
s_nop 0
buffer_load_dwordx4 v13, s[12:15], s57 offen lds
buffer_load_dwordx4 v14, s[12:15], s57 offen offset:1024 lds
s_add_u32 m0, s54, 16384
s_nop 0
buffer_load_dwordx4 v4, s[4:7], s56 offen offset:0 lds
buffer_load_dwordx4 v5, s[4:7], s56 offen offset:1024 lds
buffer_load_dwordx4 v6, s[4:7], s56 offen offset:2048 lds
buffer_load_dwordx4 v7, s[4:7], s56 offen offset:3072 lds
s_add_u32 m0, s54, 20480
s_nop 0
buffer_load_dwordx4 v8, s[4:7], s56 offen offset:0 lds
buffer_load_dwordx4 v9, s[4:7], s56 offen offset:1024 lds
buffer_load_dwordx4 v10, s[4:7], s56 offen offset:2048 lds
buffer_load_dwordx4 v11, s[4:7], s56 offen offset:3072 lds
s_add_u32 s56, s22, s20
s_and_b32 s56, s56, 3
s_add_u32 s57, s22, s21
s_and_b32 s57, s57, 12
s_or_b32 s56, s56, s57
s_lshr_b64 s[22:23], s[22:23], 4
s_mul_i32 s57, s56, 458752
s_lshl_b32 s56, s56, 7
s_waitcnt vmcnt(12)
s_barrier
s_add_u32 m0, s55, 0
s_nop 0
buffer_load_dwordx4 v13, s[8:11], s57 offen lds
buffer_load_dwordx4 v14, s[8:11], s57 offen offset:1024 lds
s_add_u32 m0, s55, 8192
s_nop 0
buffer_load_dwordx4 v13, s[12:15], s57 offen lds
buffer_load_dwordx4 v14, s[12:15], s57 offen offset:1024 lds
s_add_u32 m0, s54, 0
s_nop 0
buffer_load_dwordx4 v4, s[4:7], s56 offen offset:0 lds
buffer_load_dwordx4 v5, s[4:7], s56 offen offset:1024 lds
buffer_load_dwordx4 v6, s[4:7], s56 offen offset:2048 lds
buffer_load_dwordx4 v7, s[4:7], s56 offen offset:3072 lds
s_add_u32 m0, s54, 4096
s_nop 0
buffer_load_dwordx4 v8, s[4:7], s56 offen offset:0 lds
buffer_load_dwordx4 v9, s[4:7], s56 offen offset:1024 lds
buffer_load_dwordx4 v10, s[4:7], s56 offen offset:2048 lds
buffer_load_dwordx4 v11, s[4:7], s56 offen offset:3072 lds
s_add_u32 s56, s22, s20
s_and_b32 s56, s56, 3
s_add_u32 s57, s22, s21
s_and_b32 s57, s57, 12
s_or_b32 s56, s56, s57
s_lshr_b64 s[22:23], s[22:23], 4
s_mul_i32 s57, s56, 458752
s_lshl_b32 s56, s56, 7
s_waitcnt vmcnt(12)
s_barrier
s_add_u32 m0, s55, 16384
s_nop 0
buffer_load_dwordx4 v13, s[8:11], s57 offen lds
buffer_load_dwordx4 v14, s[8:11], s57 offen offset:1024 lds
s_add_u32 m0, s55, 24576
s_nop 0
buffer_load_dwordx4 v13, s[12:15], s57 offen lds
buffer_load_dwordx4 v14, s[12:15], s57 offen offset:1024 lds
s_add_u32 m0, s54, 8192
s_nop 0
buffer_load_dwordx4 v4, s[4:7], s56 offen offset:0 lds
buffer_load_dwordx4 v5, s[4:7], s56 offen offset:1024 lds
buffer_load_dwordx4 v6, s[4:7], s56 offen offset:2048 lds
buffer_load_dwordx4 v7, s[4:7], s56 offen offset:3072 lds
s_add_u32 m0, s54, 12288
s_nop 0
buffer_load_dwordx4 v8, s[4:7], s56 offen offset:0 lds
buffer_load_dwordx4 v9, s[4:7], s56 offen offset:1024 lds
buffer_load_dwordx4 v10, s[4:7], s56 offen offset:2048 lds
buffer_load_dwordx4 v11, s[4:7], s56 offen offset:3072 lds
s_add_u32 s56, s22, s20
s_and_b32 s56, s56, 3
s_add_u32 s57, s22, s21
s_and_b32 s57, s57, 12
s_or_b32 s56, s56, s57
s_lshr_b64 s[22:23], s[22:23], 4
s_mul_i32 s57, s56, 458752
s_lshl_b32 s56, s56, 7
s_waitcnt vmcnt(12)
s_barrier
s_add_u32 m0, s55, 32768
s_nop 0
buffer_load_dwordx4 v13, s[8:11], s57 offen lds
buffer_load_dwordx4 v14, s[8:11], s57 offen offset:1024 lds
s_add_u32 m0, s55, 40960
s_nop 0
buffer_load_dwordx4 v13, s[12:15], s57 offen lds
buffer_load_dwordx4 v14, s[12:15], s57 offen offset:1024 lds
s_add_u32 m0, s54, 16384
s_nop 0
buffer_load_dwordx4 v4, s[4:7], s56 offen offset:0 lds
buffer_load_dwordx4 v5, s[4:7], s56 offen offset:1024 lds
buffer_load_dwordx4 v6, s[4:7], s56 offen offset:2048 lds
buffer_load_dwordx4 v7, s[4:7], s56 offen offset:3072 lds
s_add_u32 m0, s54, 20480
s_nop 0
buffer_load_dwordx4 v8, s[4:7], s56 offen offset:0 lds
buffer_load_dwordx4 v9, s[4:7], s56 offen offset:1024 lds
buffer_load_dwordx4 v10, s[4:7], s56 offen offset:2048 lds
buffer_load_dwordx4 v11, s[4:7], s56 offen offset:3072 lds
s_add_u32 s56, s22, s20
s_and_b32 s56, s56, 3
s_add_u32 s57, s22, s21
s_and_b32 s57, s57, 12
s_or_b32 s56, s56, s57
s_lshr_b64 s[22:23], s[22:23], 4
s_mul_i32 s57, s56, 458752
s_lshl_b32 s56, s56, 7
s_waitcnt vmcnt(12)
s_barrier
s_add_u32 m0, s55, 0
s_nop 0
buffer_load_dwordx4 v13, s[8:11], s57 offen lds
buffer_load_dwordx4 v14, s[8:11], s57 offen offset:1024 lds
s_add_u32 m0, s55, 8192
s_nop 0
buffer_load_dwordx4 v13, s[12:15], s57 offen lds
buffer_load_dwordx4 v14, s[12:15], s57 offen offset:1024 lds
s_add_u32 m0, s54, 0
s_nop 0
buffer_load_dwordx4 v4, s[4:7], s56 offen offset:0 lds
buffer_load_dwordx4 v5, s[4:7], s56 offen offset:1024 lds
buffer_load_dwordx4 v6, s[4:7], s56 offen offset:2048 lds
buffer_load_dwordx4 v7, s[4:7], s56 offen offset:3072 lds
s_add_u32 m0, s54, 4096
s_nop 0
buffer_load_dwordx4 v8, s[4:7], s56 offen offset:0 lds
buffer_load_dwordx4 v9, s[4:7], s56 offen offset:1024 lds
buffer_load_dwordx4 v10, s[4:7], s56 offen offset:2048 lds
buffer_load_dwordx4 v11, s[4:7], s56 offen offset:3072 lds
s_add_u32 s56, s22, s20
s_and_b32 s56, s56, 3
s_add_u32 s57, s22, s21
s_and_b32 s57, s57, 12
s_or_b32 s56, s56, s57
s_lshr_b64 s[22:23], s[22:23], 4
s_mul_i32 s57, s56, 458752
s_lshl_b32 s56, s56, 7
s_waitcnt vmcnt(12)
s_barrier
s_add_u32 m0, s55, 16384
s_nop 0
buffer_load_dwordx4 v13, s[8:11], s57 offen lds
buffer_load_dwordx4 v14, s[8:11], s57 offen offset:1024 lds
s_add_u32 m0, s55, 24576
s_nop 0
buffer_load_dwordx4 v13, s[12:15], s57 offen lds
buffer_load_dwordx4 v14, s[12:15], s57 offen offset:1024 lds
s_add_u32 m0, s54, 8192
s_nop 0
buffer_load_dwordx4 v4, s[4:7], s56 offen offset:0 lds
buffer_load_dwordx4 v5, s[4:7], s56 offen offset:1024 lds
buffer_load_dwordx4 v6, s[4:7], s56 offen offset:2048 lds
buffer_load_dwordx4 v7, s[4:7], s56 offen offset:3072 lds
s_add_u32 m0, s54, 12288
s_nop 0
buffer_load_dwordx4 v8, s[4:7], s56 offen offset:0 lds
buffer_load_dwordx4 v9, s[4:7], s56 offen offset:1024 lds
buffer_load_dwordx4 v10, s[4:7], s56 offen offset:2048 lds
buffer_load_dwordx4 v11, s[4:7], s56 offen offset:3072 lds
s_add_u32 s56, s22, s20
s_and_b32 s56, s56, 3
s_add_u32 s57, s22, s21
s_and_b32 s57, s57, 12
s_or_b32 s56, s56, s57
s_lshr_b64 s[22:23], s[22:23], 4
s_mul_i32 s57, s56, 458752
s_lshl_b32 s56, s56, 7
s_waitcnt vmcnt(12)
s_barrier
s_add_u32 m0, s55, 32768
s_nop 0
buffer_load_dwordx4 v13, s[8:11], s57 offen lds
buffer_load_dwordx4 v14, s[8:11], s57 offen offset:1024 lds
s_add_u32 m0, s55, 40960
s_nop 0
buffer_load_dwordx4 v13, s[12:15], s57 offen lds
buffer_load_dwordx4 v14, s[12:15], s57 offen offset:1024 lds
s_add_u32 m0, s54, 16384
s_nop 0
buffer_load_dwordx4 v4, s[4:7], s56 offen offset:0 lds
buffer_load_dwordx4 v5, s[4:7], s56 offen offset:1024 lds
buffer_load_dwordx4 v6, s[4:7], s56 offen offset:2048 lds
buffer_load_dwordx4 v7, s[4:7], s56 offen offset:3072 lds
s_add_u32 m0, s54, 20480
s_nop 0
buffer_load_dwordx4 v8, s[4:7], s56 offen offset:0 lds
buffer_load_dwordx4 v9, s[4:7], s56 offen offset:1024 lds
buffer_load_dwordx4 v10, s[4:7], s56 offen offset:2048 lds
buffer_load_dwordx4 v11, s[4:7], s56 offen offset:3072 lds
s_add_u32 s56, s22, s20
s_and_b32 s56, s56, 3
s_add_u32 s57, s22, s21
s_and_b32 s57, s57, 12
s_or_b32 s56, s56, s57
s_lshr_b64 s[22:23], s[22:23], 4
s_mul_i32 s57, s56, 458752
s_lshl_b32 s56, s56, 7
s_waitcnt vmcnt(12)
s_barrier
s_add_u32 m0, s55, 0
s_nop 0
buffer_load_dwordx4 v13, s[8:11], s57 offen lds
buffer_load_dwordx4 v14, s[8:11], s57 offen offset:1024 lds
s_add_u32 m0, s55, 8192
s_nop 0
buffer_load_dwordx4 v13, s[12:15], s57 offen lds
buffer_load_dwordx4 v14, s[12:15], s57 offen offset:1024 lds
s_add_u32 m0, s54, 0
s_nop 0
buffer_load_dwordx4 v4, s[4:7], s56 offen offset:0 lds
buffer_load_dwordx4 v5, s[4:7], s56 offen offset:1024 lds
buffer_load_dwordx4 v6, s[4:7], s56 offen offset:2048 lds
buffer_load_dwordx4 v7, s[4:7], s56 offen offset:3072 lds
s_add_u32 m0, s54, 4096
s_nop 0
buffer_load_dwordx4 v8, s[4:7], s56 offen offset:0 lds
buffer_load_dwordx4 v9, s[4:7], s56 offen offset:1024 lds
buffer_load_dwordx4 v10, s[4:7], s56 offen offset:2048 lds
buffer_load_dwordx4 v11, s[4:7], s56 offen offset:3072 lds
s_add_u32 s56, s22, s20
s_and_b32 s56, s56, 3
s_add_u32 s57, s22, s21
s_and_b32 s57, s57, 12
s_or_b32 s56, s56, s57
s_lshr_b64 s[22:23], s[22:23], 4
s_mul_i32 s57, s56, 458752
s_lshl_b32 s56, s56, 7
s_waitcnt vmcnt(12)
s_barrier
s_add_u32 m0, s55, 16384
s_nop 0
buffer_load_dwordx4 v13, s[8:11], s57 offen lds
buffer_load_dwordx4 v14, s[8:11], s57 offen offset:1024 lds
s_add_u32 m0, s55, 24576
s_nop 0
buffer_load_dwordx4 v13, s[12:15], s57 offen lds
buffer_load_dwordx4 v14, s[12:15], s57 offen offset:1024 lds
s_add_u32 m0, s54, 8192
s_nop 0
buffer_load_dwordx4 v4, s[4:7], s56 offen offset:0 lds
buffer_load_dwordx4 v5, s[4:7], s56 offen offset:1024 lds
buffer_load_dwordx4 v6, s[4:7], s56 offen offset:2048 lds
buffer_load_dwordx4 v7, s[4:7], s56 offen offset:3072 lds
s_add_u32 m0, s54, 12288
s_nop 0
buffer_load_dwordx4 v8, s[4:7], s56 offen offset:0 lds
buffer_load_dwordx4 v9, s[4:7], s56 offen offset:1024 lds
buffer_load_dwordx4 v10, s[4:7], s56 offen offset:2048 lds
buffer_load_dwordx4 v11, s[4:7], s56 offen offset:3072 lds
s_add_u32 s56, s22, s20
s_and_b32 s56, s56, 3
s_add_u32 s57, s22, s21
s_and_b32 s57, s57, 12
s_or_b32 s56, s56, s57
s_lshr_b64 s[22:23], s[22:23], 4
s_mul_i32 s57, s56, 458752
s_lshl_b32 s56, s56, 7
s_waitcnt vmcnt(12)
s_barrier
s_add_u32 m0, s55, 32768
s_nop 0
buffer_load_dwordx4 v13, s[8:11], s57 offen lds
buffer_load_dwordx4 v14, s[8:11], s57 offen offset:1024 lds
s_add_u32 m0, s55, 40960
s_nop 0
buffer_load_dwordx4 v13, s[12:15], s57 offen lds
buffer_load_dwordx4 v14, s[12:15], s57 offen offset:1024 lds
s_add_u32 m0, s54, 16384
s_nop 0
buffer_load_dwordx4 v4, s[4:7], s56 offen offset:0 lds
buffer_load_dwordx4 v5, s[4:7], s56 offen offset:1024 lds
buffer_load_dwordx4 v6, s[4:7], s56 offen offset:2048 lds
buffer_load_dwordx4 v7, s[4:7], s56 offen offset:3072 lds
s_add_u32 m0, s54, 20480
s_nop 0
buffer_load_dwordx4 v8, s[4:7], s56 offen offset:0 lds
buffer_load_dwordx4 v9, s[4:7], s56 offen offset:1024 lds
buffer_load_dwordx4 v10, s[4:7], s56 offen offset:2048 lds
buffer_load_dwordx4 v11, s[4:7], s56 offen offset:3072 lds
s_add_u32 s56, s22, s20
s_and_b32 s56, s56, 3
s_add_u32 s57, s22, s21
s_and_b32 s57, s57, 12
s_or_b32 s56, s56, s57
s_lshr_b64 s[22:23], s[22:23], 4
s_mul_i32 s57, s56, 458752
s_lshl_b32 s56, s56, 7
s_waitcnt vmcnt(12)
s_barrier
s_add_u32 m0, s55, 0
s_nop 0
buffer_load_dwordx4 v13, s[8:11], s57 offen lds
buffer_load_dwordx4 v14, s[8:11], s57 offen offset:1024 lds
s_add_u32 m0, s55, 8192
s_nop 0
buffer_load_dwordx4 v13, s[12:15], s57 offen lds
buffer_load_dwordx4 v14, s[12:15], s57 offen offset:1024 lds
s_add_u32 m0, s54, 0
s_nop 0
buffer_load_dwordx4 v4, s[4:7], s56 offen offset:0 lds
buffer_load_dwordx4 v5, s[4:7], s56 offen offset:1024 lds
buffer_load_dwordx4 v6, s[4:7], s56 offen offset:2048 lds
buffer_load_dwordx4 v7, s[4:7], s56 offen offset:3072 lds
s_add_u32 m0, s54, 4096
s_nop 0
buffer_load_dwordx4 v8, s[4:7], s56 offen offset:0 lds
buffer_load_dwordx4 v9, s[4:7], s56 offen offset:1024 lds
buffer_load_dwordx4 v10, s[4:7], s56 offen offset:2048 lds
buffer_load_dwordx4 v11, s[4:7], s56 offen offset:3072 lds
s_add_u32 s56, s22, s20
s_and_b32 s56, s56, 3
s_add_u32 s57, s22, s21
s_and_b32 s57, s57, 12
s_or_b32 s56, s56, s57
s_lshr_b64 s[22:23], s[22:23], 4
s_mul_i32 s57, s56, 458752
s_lshl_b32 s56, s56, 7
s_waitcnt vmcnt(12)
s_barrier
s_add_u32 m0, s55, 16384
s_nop 0
buffer_load_dwordx4 v13, s[8:11], s57 offen lds
buffer_load_dwordx4 v14, s[8:11], s57 offen offset:1024 lds
s_add_u32 m0, s55, 24576
s_nop 0
buffer_load_dwordx4 v13, s[12:15], s57 offen lds
buffer_load_dwordx4 v14, s[12:15], s57 offen offset:1024 lds
s_add_u32 m0, s54, 8192
s_nop 0
buffer_load_dwordx4 v4, s[4:7], s56 offen offset:0 lds
buffer_load_dwordx4 v5, s[4:7], s56 offen offset:1024 lds
buffer_load_dwordx4 v6, s[4:7], s56 offen offset:2048 lds
buffer_load_dwordx4 v7, s[4:7], s56 offen offset:3072 lds
s_add_u32 m0, s54, 12288
s_nop 0
buffer_load_dwordx4 v8, s[4:7], s56 offen offset:0 lds
buffer_load_dwordx4 v9, s[4:7], s56 offen offset:1024 lds
buffer_load_dwordx4 v10, s[4:7], s56 offen offset:2048 lds
buffer_load_dwordx4 v11, s[4:7], s56 offen offset:3072 lds
s_add_u32 s56, s22, s20
s_and_b32 s56, s56, 3
s_add_u32 s57, s22, s21
s_and_b32 s57, s57, 12
s_or_b32 s56, s56, s57
s_lshr_b64 s[22:23], s[22:23], 4
s_mul_i32 s57, s56, 458752
s_lshl_b32 s56, s56, 7
s_waitcnt vmcnt(12)
s_barrier
s_add_u32 m0, s59, 147456
s_nop 0
buffer_load_dwordx4 v16, s[24:27], s58 offen offset:0 lds
buffer_load_dwordx4 v17, s[24:27], s58 offen offset:1024 lds
buffer_load_dwordx4 v18, s[24:27], s58 offen offset:2048 lds
buffer_load_dwordx4 v19, s[24:27], s58 offen offset:3072 lds
s_add_u32 s58, s58, 65536
s_add_u32 m0, s55, 32768
s_nop 0
buffer_load_dwordx4 v13, s[8:11], s57 offen lds
buffer_load_dwordx4 v14, s[8:11], s57 offen offset:1024 lds
s_add_u32 m0, s55, 40960
s_nop 0
buffer_load_dwordx4 v13, s[12:15], s57 offen lds
buffer_load_dwordx4 v14, s[12:15], s57 offen offset:1024 lds
s_add_u32 m0, s54, 16384
s_nop 0
buffer_load_dwordx4 v4, s[4:7], s56 offen offset:0 lds
buffer_load_dwordx4 v5, s[4:7], s56 offen offset:1024 lds
buffer_load_dwordx4 v6, s[4:7], s56 offen offset:2048 lds
buffer_load_dwordx4 v7, s[4:7], s56 offen offset:3072 lds
s_add_u32 m0, s54, 20480
s_nop 0
buffer_load_dwordx4 v8, s[4:7], s56 offen offset:0 lds
buffer_load_dwordx4 v9, s[4:7], s56 offen offset:1024 lds
buffer_load_dwordx4 v10, s[4:7], s56 offen offset:2048 lds
buffer_load_dwordx4 v11, s[4:7], s56 offen offset:3072 lds
s_add_u32 s56, s22, s20
s_and_b32 s56, s56, 3
s_add_u32 s57, s22, s21
s_and_b32 s57, s57, 12
s_or_b32 s56, s56, s57
s_lshr_b64 s[22:23], s[22:23], 4
s_mul_i32 s57, s56, 458752
s_lshl_b32 s56, s56, 7
s_waitcnt vmcnt(16)
s_barrier
s_add_u32 m0, s55, 0
s_nop 0
buffer_load_dwordx4 v13, s[8:11], s57 offen lds
buffer_load_dwordx4 v14, s[8:11], s57 offen offset:1024 lds
s_add_u32 m0, s55, 8192
s_nop 0
buffer_load_dwordx4 v13, s[12:15], s57 offen lds
buffer_load_dwordx4 v14, s[12:15], s57 offen offset:1024 lds
s_add_u32 m0, s54, 0
s_nop 0
buffer_load_dwordx4 v4, s[4:7], s56 offen offset:0 lds
buffer_load_dwordx4 v5, s[4:7], s56 offen offset:1024 lds
buffer_load_dwordx4 v6, s[4:7], s56 offen offset:2048 lds
buffer_load_dwordx4 v7, s[4:7], s56 offen offset:3072 lds
s_add_u32 m0, s54, 4096
s_nop 0
buffer_load_dwordx4 v8, s[4:7], s56 offen offset:0 lds
buffer_load_dwordx4 v9, s[4:7], s56 offen offset:1024 lds
buffer_load_dwordx4 v10, s[4:7], s56 offen offset:2048 lds
buffer_load_dwordx4 v11, s[4:7], s56 offen offset:3072 lds
s_waitcnt vmcnt(12)
s_barrier
ds_read_b64_tr_b16 v[32:33], v24 offset:0
ds_read_b64_tr_b16 v[34:35], v24 offset:2048
ds_read_b64_tr_b16 v[36:37], v25 offset:0
ds_read_b64_tr_b16 v[38:39], v25 offset:2048
ds_read_b64_tr_b16 v[40:41], v26 offset:0
ds_read_b64_tr_b16 v[42:43], v26 offset:2048
ds_read_b64_tr_b16 v[44:45], v27 offset:0
ds_read_b64_tr_b16 v[46:47], v27 offset:2048
v_mov_b32 v29, 0
s_mov_b64 exec, 1
ds_write_b32 v22, v29
s_mov_b64 exec, -1
s_add_u32 m0, s54, 8192
s_nop 0
buffer_load_dwordx4 v16, s[24:27], s58 offen offset:0 lds
buffer_load_dwordx4 v17, s[24:27], s58 offen offset:1024 lds
buffer_load_dwordx4 v18, s[24:27], s58 offen offset:2048 lds
buffer_load_dwordx4 v19, s[24:27], s58 offen offset:3072 lds
s_add_u32 s58, s58, 65536
s_add_u32 m0, s54, 12288
s_nop 0
buffer_load_dwordx4 v16, s[24:27], s58 offen offset:0 lds
buffer_load_dwordx4 v17, s[24:27], s58 offen offset:1024 lds
buffer_load_dwordx4 v18, s[24:27], s58 offen offset:2048 lds
buffer_load_dwordx4 v19, s[24:27], s58 offen offset:3072 lds
s_add_u32 s58, s58, 65536
s_add_u32 m0, s59, 16384
s_nop 0
buffer_load_dwordx4 v16, s[24:27], s58 offen offset:0 lds
buffer_load_dwordx4 v17, s[24:27], s58 offen offset:1024 lds
buffer_load_dwordx4 v18, s[24:27], s58 offen offset:2048 lds
buffer_load_dwordx4 v19, s[24:27], s58 offen offset:3072 lds
s_add_u32 s58, s58, 65536
s_add_u32 s53, s54, 0
s_add_u32 s52, s44, 0
v_add_u32 v4, s53, v20
v_add_u32 v6, s52, v20
v_add_u32 v5, s53, v21
v_add_u32 v7, s52, v21
s_add_u32 s53, s59, 0
s_add_u32 s52, s45, 0
v_add_u32 v8, s53, v20
v_add_u32 v10, s52, v20
v_add_u32 v9, s53, v21
v_add_u32 v11, s52, v21
s_waitcnt vmcnt(12)
s_waitcnt lgkmcnt(0)
s_barrier
s_add_u32 m0, s54, 16384
s_nop 0
buffer_load_dwordx4 v16, s[24:27], s58 offen offset:0 lds
buffer_load_dwordx4 v17, s[24:27], s58 offen offset:1024 lds
buffer_load_dwordx4 v18, s[24:27], s58 offen offset:2048 lds
buffer_load_dwordx4 v19, s[24:27], s58 offen offset:3072 lds
s_add_u32 s58, s58, 65536
s_add_u32 m0, s54, 20480
s_nop 0
buffer_load_dwordx4 v16, s[24:27], s58 offen offset:0 lds
buffer_load_dwordx4 v17, s[24:27], s58 offen offset:1024 lds
buffer_load_dwordx4 v18, s[24:27], s58 offen offset:2048 lds
buffer_load_dwordx4 v19, s[24:27], s58 offen offset:3072 lds
s_add_u32 s58, s58, 65536
s_add_u32 m0, s59, 32768
s_nop 0
buffer_load_dwordx4 v16, s[24:27], s58 offen offset:0 lds
buffer_load_dwordx4 v17, s[24:27], s58 offen offset:1024 lds
buffer_load_dwordx4 v18, s[24:27], s58 offen offset:2048 lds
buffer_load_dwordx4 v19, s[24:27], s58 offen offset:3072 lds
s_add_u32 s58, s58, 65536
s_barrier
s_waitcnt vmcnt(16)
v_mov_b32 v29, 1
s_mov_b64 exec, 1
ds_write_b32 v22, v29
s_mov_b64 exec, -1
ds_read_b64_tr_b16 v[48:49], v4 offset:8192
ds_read_b64_tr_b16 v[50:51], v4 offset:10240
ds_read_b64_tr_b16 v[52:53], v5 offset:8192
ds_read_b64_tr_b16 v[54:55], v5 offset:10240
ds_read_b64_tr_b16 v[64:65], v4 offset:12288
ds_read_b64_tr_b16 v[66:67], v4 offset:14336
ds_read_b64_tr_b16 v[68:69], v5 offset:12288
ds_read_b64_tr_b16 v[70:71], v5 offset:14336
L_pw1_0:
ds_read_b32 v30, v23
s_waitcnt lgkmcnt(0)
v_cmp_gt_u32 vcc, 1, v30
s_cbranch_vccnz L_pw1_0
ds_read_b64_tr_b16 v[56:57], v6 offset:8192
ds_read_b64_tr_b16 v[58:59], v6 offset:10240
ds_read_b64_tr_b16 v[60:61], v7 offset:8192
ds_read_b64_tr_b16 v[62:63], v7 offset:10240
ds_read_b64_tr_b16 v[72:73], v6 offset:12288
ds_read_b64_tr_b16 v[74:75], v6 offset:14336
ds_read_b64_tr_b16 v[76:77], v7 offset:12288
ds_read_b64_tr_b16 v[78:79], v7 offset:14336
s_waitcnt vmcnt(8)
v_mov_b32 v29, 2
s_mov_b64 exec, 1
ds_write_b32 v22, v29
s_mov_b64 exec, -1
ds_read_b64_tr_b16 v[80:81], v8 offset:16384
ds_read_b64_tr_b16 v[82:83], v8 offset:18432
ds_read_b64_tr_b16 v[84:85], v9 offset:16384
ds_read_b64_tr_b16 v[86:87], v9 offset:18432
ds_read_b64_tr_b16 v[96:97], v4 offset:16384
ds_read_b64_tr_b16 v[98:99], v4 offset:18432
ds_read_b64_tr_b16 v[100:101], v5 offset:16384
ds_read_b64_tr_b16 v[102:103], v5 offset:18432
L_pw1_1:
ds_read_b32 v30, v23
s_waitcnt lgkmcnt(0)
v_cmp_gt_u32 vcc, 2, v30
s_cbranch_vccnz L_pw1_1
s_add_u32 m0, s54, 8192
s_nop 0
buffer_load_dwordx4 v16, s[24:27], s58 offen offset:0 lds
buffer_load_dwordx4 v17, s[24:27], s58 offen offset:1024 lds
buffer_load_dwordx4 v18, s[24:27], s58 offen offset:2048 lds
buffer_load_dwordx4 v19, s[24:27], s58 offen offset:3072 lds
s_add_u32 s58, s58, 65536
ds_read_b64_tr_b16 v[88:89], v10 offset:16384
ds_read_b64_tr_b16 v[90:91], v10 offset:18432
ds_read_b64_tr_b16 v[92:93], v11 offset:16384
ds_read_b64_tr_b16 v[94:95], v11 offset:18432
s_add_u32 m0, s54, 12288
s_nop 0
buffer_load_dwordx4 v16, s[24:27], s58 offen offset:0 lds
buffer_load_dwordx4 v17, s[24:27], s58 offen offset:1024 lds
buffer_load_dwordx4 v18, s[24:27], s58 offen offset:2048 lds
buffer_load_dwordx4 v19, s[24:27], s58 offen offset:3072 lds
s_add_u32 s58, s58, 65536
ds_read_b64_tr_b16 v[104:105], v6 offset:16384
ds_read_b64_tr_b16 v[106:107], v6 offset:18432
ds_read_b64_tr_b16 v[108:109], v7 offset:16384
ds_read_b64_tr_b16 v[110:111], v7 offset:18432
s_waitcnt vmcnt(8)
v_mov_b32 v29, 3
s_mov_b64 exec, 1
ds_write_b32 v22, v29
s_mov_b64 exec, -1
ds_read_b64_tr_b16 v[112:113], v4 offset:20480
ds_read_b64_tr_b16 v[114:115], v4 offset:22528
ds_read_b64_tr_b16 v[116:117], v5 offset:20480
ds_read_b64_tr_b16 v[118:119], v5 offset:22528
ds_read_b64_tr_b16 v[128:129], v8 offset:32768
ds_read_b64_tr_b16 v[130:131], v8 offset:34816
ds_read_b64_tr_b16 v[132:133], v9 offset:32768
ds_read_b64_tr_b16 v[134:135], v9 offset:34816
L_pw1_2:
ds_read_b32 v30, v23
s_waitcnt lgkmcnt(0)
v_cmp_gt_u32 vcc, 3, v30
s_cbranch_vccnz L_pw1_2
s_add_u32 m0, s59, 16384
s_nop 0
buffer_load_dwordx4 v16, s[24:27], s58 offen offset:0 lds
buffer_load_dwordx4 v17, s[24:27], s58 offen offset:1024 lds
buffer_load_dwordx4 v18, s[24:27], s58 offen offset:2048 lds
buffer_load_dwordx4 v19, s[24:27], s58 offen offset:3072 lds
s_add_u32 s58, s58, 65536
ds_read_b64_tr_b16 v[120:121], v6 offset:20480
ds_read_b64_tr_b16 v[122:123], v6 offset:22528
ds_read_b64_tr_b16 v[124:125], v7 offset:20480
ds_read_b64_tr_b16 v[126:127], v7 offset:22528
s_add_u32 m0, s54, 16384
s_nop 0
buffer_load_dwordx4 v16, s[24:27], s58 offen offset:0 lds
buffer_load_dwordx4 v17, s[24:27], s58 offen offset:1024 lds
buffer_load_dwordx4 v18, s[24:27], s58 offen offset:2048 lds
buffer_load_dwordx4 v19, s[24:27], s58 offen offset:3072 lds
s_add_u32 s58, s58, 65536
ds_read_b64_tr_b16 v[136:137], v10 offset:32768
ds_read_b64_tr_b16 v[138:139], v10 offset:34816
ds_read_b64_tr_b16 v[140:141], v11 offset:32768
ds_read_b64_tr_b16 v[142:143], v11 offset:34816
s_waitcnt vmcnt(8)
v_mov_b32 v29, 4
s_mov_b64 exec, 1
ds_write_b32 v22, v29
s_mov_b64 exec, -1
ds_read_b64_tr_b16 v[144:145], v4 offset:8192
ds_read_b64_tr_b16 v[146:147], v4 offset:10240
ds_read_b64_tr_b16 v[148:149], v5 offset:8192
ds_read_b64_tr_b16 v[150:151], v5 offset:10240
ds_read_b64_tr_b16 v[160:161], v4 offset:12288
ds_read_b64_tr_b16 v[162:163], v4 offset:14336
ds_read_b64_tr_b16 v[164:165], v5 offset:12288
ds_read_b64_tr_b16 v[166:167], v5 offset:14336
L_pw1_3:
ds_read_b32 v30, v23
s_waitcnt lgkmcnt(0)
v_cmp_gt_u32 vcc, 4, v30
s_cbranch_vccnz L_pw1_3
s_add_u32 m0, s54, 20480
s_nop 0
buffer_load_dwordx4 v16, s[24:27], s58 offen offset:0 lds
buffer_load_dwordx4 v17, s[24:27], s58 offen offset:1024 lds
buffer_load_dwordx4 v18, s[24:27], s58 offen offset:2048 lds
buffer_load_dwordx4 v19, s[24:27], s58 offen offset:3072 lds
s_add_u32 s58, s58, 65536
ds_read_b64_tr_b16 v[152:153], v6 offset:8192
ds_read_b64_tr_b16 v[154:155], v6 offset:10240
ds_read_b64_tr_b16 v[156:157], v7 offset:8192
ds_read_b64_tr_b16 v[158:159], v7 offset:10240
s_add_u32 m0, s59, 32768
s_nop 0
buffer_load_dwordx4 v16, s[24:27], s58 offen offset:0 lds
buffer_load_dwordx4 v17, s[24:27], s58 offen offset:1024 lds
buffer_load_dwordx4 v18, s[24:27], s58 offen offset:2048 lds
buffer_load_dwordx4 v19, s[24:27], s58 offen offset:3072 lds
s_add_u32 s58, s58, 65536
ds_read_b64_tr_b16 v[168:169], v6 offset:12288
ds_read_b64_tr_b16 v[170:171], v6 offset:14336
ds_read_b64_tr_b16 v[172:173], v7 offset:12288
ds_read_b64_tr_b16 v[174:175], v7 offset:14336
s_waitcnt vmcnt(8)
v_mov_b32 v29, 5
s_mov_b64 exec, 1
ds_write_b32 v22, v29
s_mov_b64 exec, -1
ds_read_b64_tr_b16 v[176:177], v8 offset:16384
ds_read_b64_tr_b16 v[178:179], v8 offset:18432
ds_read_b64_tr_b16 v[180:181], v9 offset:16384
ds_read_b64_tr_b16 v[182:183], v9 offset:18432
ds_read_b64_tr_b16 v[192:193], v4 offset:16384
ds_read_b64_tr_b16 v[194:195], v4 offset:18432
ds_read_b64_tr_b16 v[196:197], v5 offset:16384
ds_read_b64_tr_b16 v[198:199], v5 offset:18432
L_pw1_4:
ds_read_b32 v30, v23
s_waitcnt lgkmcnt(0)
v_cmp_gt_u32 vcc, 5, v30
s_cbranch_vccnz L_pw1_4
s_add_u32 m0, s54, 8192
s_nop 0
buffer_load_dwordx4 v16, s[24:27], s58 offen offset:0 lds
buffer_load_dwordx4 v17, s[24:27], s58 offen offset:1024 lds
buffer_load_dwordx4 v18, s[24:27], s58 offen offset:2048 lds
buffer_load_dwordx4 v19, s[24:27], s58 offen offset:3072 lds
s_add_u32 s58, s58, 65536
ds_read_b64_tr_b16 v[184:185], v10 offset:16384
ds_read_b64_tr_b16 v[186:187], v10 offset:18432
ds_read_b64_tr_b16 v[188:189], v11 offset:16384
ds_read_b64_tr_b16 v[190:191], v11 offset:18432
ds_read_b64_tr_b16 v[200:201], v6 offset:16384
ds_read_b64_tr_b16 v[202:203], v6 offset:18432
ds_read_b64_tr_b16 v[204:205], v7 offset:16384
ds_read_b64_tr_b16 v[206:207], v7 offset:18432
s_waitcnt vmcnt(4)
v_mov_b32 v29, 6
s_mov_b64 exec, 1
ds_write_b32 v22, v29
s_mov_b64 exec, -1
ds_read_b64_tr_b16 v[208:209], v4 offset:20480
ds_read_b64_tr_b16 v[210:211], v4 offset:22528
ds_read_b64_tr_b16 v[212:213], v5 offset:20480
ds_read_b64_tr_b16 v[214:215], v5 offset:22528
ds_read_b64_tr_b16 v[224:225], v8 offset:32768
ds_read_b64_tr_b16 v[226:227], v8 offset:34816
ds_read_b64_tr_b16 v[228:229], v9 offset:32768
ds_read_b64_tr_b16 v[230:231], v9 offset:34816
L_pw1_5:
ds_read_b32 v30, v23
s_waitcnt lgkmcnt(0)
v_cmp_gt_u32 vcc, 6, v30
s_cbranch_vccnz L_pw1_5
ds_read_b64_tr_b16 v[216:217], v6 offset:20480
ds_read_b64_tr_b16 v[218:219], v6 offset:22528
ds_read_b64_tr_b16 v[220:221], v7 offset:20480
ds_read_b64_tr_b16 v[222:223], v7 offset:22528
ds_read_b64_tr_b16 v[232:233], v10 offset:32768
ds_read_b64_tr_b16 v[234:235], v10 offset:34816
ds_read_b64_tr_b16 v[236:237], v11 offset:32768
ds_read_b64_tr_b16 v[238:239], v11 offset:34816
s_waitcnt vmcnt(0)
v_mov_b32 v29, 7
s_mov_b64 exec, 1
ds_write_b32 v22, v29
s_mov_b64 exec, -1
ds_read_b64_tr_b16 v[240:241], v4 offset:8192
ds_read_b64_tr_b16 v[242:243], v4 offset:10240
ds_read_b64_tr_b16 v[244:245], v5 offset:8192
ds_read_b64_tr_b16 v[246:247], v5 offset:10240
L_pw1_6:
ds_read_b32 v30, v23
s_waitcnt lgkmcnt(0)
v_cmp_gt_u32 vcc, 7, v30
s_cbranch_vccnz L_pw1_6
ds_read_b64_tr_b16 v[248:249], v6 offset:8192
ds_read_b64_tr_b16 v[250:251], v6 offset:10240
ds_read_b64_tr_b16 v[252:253], v7 offset:8192
ds_read_b64_tr_b16 v[254:255], v7 offset:10240
L_hpoll:
s_waitcnt lgkmcnt(0)
s_barrier
ds_read_b128 v[16:19], v0 offset:0
ds_read_b128 v[20:23], v0 offset:1024
ds_read_b128 v[24:27], v0 offset:2048
ds_read_b128 v[28:31], v0 offset:3072
s_waitcnt lgkmcnt(3)
v_mfma_f32_16x16x32_bf16 v[4:7], v[32:35], v[16:19], 0
v_mfma_f32_16x16x32_bf16 v[8:11], v[36:39], v[16:19], 0
ds_read_b128 v[16:19], v0 offset:4096
s_waitcnt lgkmcnt(3)
v_mfma_f32_16x16x32_bf16 v[4:7], v[48:51], v[20:23], v[4:7]
v_mfma_f32_16x16x32_bf16 v[8:11], v[52:55], v[20:23], v[8:11]
ds_read_b128 v[20:23], v0 offset:5120
s_waitcnt lgkmcnt(3)
v_mfma_f32_16x16x32_bf16 v[4:7], v[64:67], v[24:27], v[4:7]
v_mfma_f32_16x16x32_bf16 v[8:11], v[68:71], v[24:27], v[8:11]
ds_read_b128 v[24:27], v0 offset:6144
s_waitcnt lgkmcnt(3)
v_mfma_f32_16x16x32_bf16 v[4:7], v[80:83], v[28:31], v[4:7]
v_mfma_f32_16x16x32_bf16 v[8:11], v[84:87], v[28:31], v[8:11]
ds_read_b128 v[28:31], v0 offset:24576
s_waitcnt lgkmcnt(3)
v_mfma_f32_16x16x32_bf16 v[4:7], v[96:99], v[16:19], v[4:7]
v_mfma_f32_16x16x32_bf16 v[8:11], v[100:103], v[16:19], v[8:11]
ds_read_b128 v[16:19], v0 offset:25600
s_waitcnt lgkmcnt(3)
v_mfma_f32_16x16x32_bf16 v[4:7], v[112:115], v[20:23], v[4:7]
v_mfma_f32_16x16x32_bf16 v[8:11], v[116:119], v[20:23], v[8:11]
ds_read_b128 v[20:23], v0 offset:26624
s_waitcnt lgkmcnt(3)
v_mfma_f32_16x16x32_bf16 v[4:7], v[128:131], v[24:27], v[4:7]
v_mfma_f32_16x16x32_bf16 v[8:11], v[132:135], v[24:27], v[8:11]
ds_read_b128 v[24:27], v0 offset:27648
s_waitcnt lgkmcnt(3)
v_mfma_f32_16x16x32_bf16 v[4:7], v[144:147], v[28:31], v[4:7]
v_mfma_f32_16x16x32_bf16 v[8:11], v[148:151], v[28:31], v[8:11]
ds_read_b128 v[28:31], v0 offset:28672
s_waitcnt lgkmcnt(3)
v_mfma_f32_16x16x32_bf16 v[4:7], v[160:163], v[16:19], v[4:7]
v_mfma_f32_16x16x32_bf16 v[8:11], v[164:167], v[16:19], v[8:11]
ds_read_b128 v[16:19], v0 offset:29696
s_waitcnt lgkmcnt(3)
v_mfma_f32_16x16x32_bf16 v[4:7], v[176:179], v[20:23], v[4:7]
v_mfma_f32_16x16x32_bf16 v[8:11], v[180:183], v[20:23], v[8:11]
ds_read_b128 v[20:23], v0 offset:30720
s_waitcnt lgkmcnt(3)
v_mfma_f32_16x16x32_bf16 v[4:7], v[192:195], v[24:27], v[4:7]
v_mfma_f32_16x16x32_bf16 v[8:11], v[196:199], v[24:27], v[8:11]
ds_read_b128 v[24:27], v1 offset:0
s_waitcnt lgkmcnt(3)
v_mfma_f32_16x16x32_bf16 v[4:7], v[208:211], v[28:31], v[4:7]
v_mfma_f32_16x16x32_bf16 v[8:11], v[212:215], v[28:31], v[8:11]
ds_read_b128 v[28:31], v1 offset:1024
s_waitcnt lgkmcnt(3)
v_mfma_f32_16x16x32_bf16 v[4:7], v[224:227], v[16:19], v[4:7]
v_mfma_f32_16x16x32_bf16 v[8:11], v[228:231], v[16:19], v[8:11]
ds_read_b128 v[16:19], v1 offset:2048
s_waitcnt lgkmcnt(3)
v_mfma_f32_16x16x32_bf16 v[4:7], v[240:243], v[20:23], v[4:7]
v_mfma_f32_16x16x32_bf16 v[8:11], v[244:247], v[20:23], v[8:11]
ds_read_b128 v[20:23], v1 offset:3072
s_waitcnt lgkmcnt(3)
v_mfma_f32_16x16x32_bf16 v[4:7], v[40:43], v[24:27], v[4:7]
v_mfma_f32_16x16x32_bf16 v[8:11], v[44:47], v[24:27], v[8:11]
ds_read_b128 v[24:27], v1 offset:4096
s_waitcnt lgkmcnt(3)
v_mfma_f32_16x16x32_bf16 v[4:7], v[56:59], v[28:31], v[4:7]
v_mfma_f32_16x16x32_bf16 v[8:11], v[60:63], v[28:31], v[8:11]
ds_read_b128 v[28:31], v1 offset:5120
s_waitcnt lgkmcnt(3)
v_mfma_f32_16x16x32_bf16 v[4:7], v[72:75], v[16:19], v[4:7]
v_mfma_f32_16x16x32_bf16 v[8:11], v[76:79], v[16:19], v[8:11]
ds_read_b128 v[16:19], v1 offset:6144
s_waitcnt lgkmcnt(3)
v_mfma_f32_16x16x32_bf16 v[4:7], v[88:91], v[20:23], v[4:7]
v_mfma_f32_16x16x32_bf16 v[8:11], v[92:95], v[20:23], v[8:11]
ds_read_b128 v[20:23], v1 offset:24576
s_waitcnt lgkmcnt(3)
v_mfma_f32_16x16x32_bf16 v[4:7], v[104:107], v[24:27], v[4:7]
v_mfma_f32_16x16x32_bf16 v[8:11], v[108:111], v[24:27], v[8:11]
ds_read_b128 v[24:27], v1 offset:25600
s_waitcnt lgkmcnt(3)
v_mfma_f32_16x16x32_bf16 v[4:7], v[120:123], v[28:31], v[4:7]
v_mfma_f32_16x16x32_bf16 v[8:11], v[124:127], v[28:31], v[8:11]
ds_read_b128 v[28:31], v1 offset:26624
s_waitcnt lgkmcnt(3)
v_mfma_f32_16x16x32_bf16 v[4:7], v[136:139], v[16:19], v[4:7]
v_mfma_f32_16x16x32_bf16 v[8:11], v[140:143], v[16:19], v[8:11]
ds_read_b128 v[16:19], v1 offset:27648
s_waitcnt lgkmcnt(3)
v_mfma_f32_16x16x32_bf16 v[4:7], v[152:155], v[20:23], v[4:7]
v_mfma_f32_16x16x32_bf16 v[8:11], v[156:159], v[20:23], v[8:11]
ds_read_b128 v[20:23], v1 offset:28672
s_waitcnt lgkmcnt(3)
v_mfma_f32_16x16x32_bf16 v[4:7], v[168:171], v[24:27], v[4:7]
v_mfma_f32_16x16x32_bf16 v[8:11], v[172:175], v[24:27], v[8:11]
ds_read_b128 v[24:27], v1 offset:29696
s_waitcnt lgkmcnt(3)
v_mfma_f32_16x16x32_bf16 v[4:7], v[184:187], v[28:31], v[4:7]
v_mfma_f32_16x16x32_bf16 v[8:11], v[188:191], v[28:31], v[8:11]
ds_read_b128 v[28:31], v1 offset:30720
s_waitcnt lgkmcnt(3)
v_mfma_f32_16x16x32_bf16 v[4:7], v[200:203], v[16:19], v[4:7]
v_mfma_f32_16x16x32_bf16 v[8:11], v[204:207], v[16:19], v[8:11]
s_barrier
v_add_u32 v0, s39, v0
ds_read_b128 v[16:19], v0 offset:0
s_waitcnt lgkmcnt(3)
v_mfma_f32_16x16x32_bf16 v[4:7], v[216:219], v[20:23], v[4:7]
v_mfma_f32_16x16x32_bf16 v[8:11], v[220:223], v[20:23], v[8:11]
ds_read_b128 v[20:23], v0 offset:1024
s_waitcnt lgkmcnt(3)
v_mfma_f32_16x16x32_bf16 v[4:7], v[232:235], v[24:27], v[4:7]
v_mfma_f32_16x16x32_bf16 v[8:11], v[236:239], v[24:27], v[8:11]
ds_read_b128 v[24:27], v0 offset:2048
s_waitcnt lgkmcnt(3)
v_mfma_f32_16x16x32_bf16 v[4:7], v[248:251], v[28:31], v[4:7]
s_nop 2
v_mfma_f32_16x16x32_bf16 v[8:11], v[252:255], v[28:31], v[8:11]
ds_read_b128 v[28:31], v0 offset:3072
s_waitcnt lgkmcnt(3)
s_nop 0
v_mfma_f32_16x16x32_bf16 v[12:15], v[32:35], v[16:19], 0
v_cvt_pk_bf16_f32 v2, v4, v5
v_cvt_pk_bf16_f32 v3, v6, v7
v_mfma_f32_16x16x32_bf16 v[4:7], v[36:39], v[16:19], 0
ds_read_b128 v[16:19], v0 offset:4096
s_waitcnt lgkmcnt(3)
v_mfma_f32_16x16x32_bf16 v[12:15], v[48:51], v[20:23], v[12:15]
v_cvt_pk_bf16_f32 v11, v10, v11
v_cvt_pk_bf16_f32 v10, v8, v9
v_mov_b32 v8, v2
v_mfma_f32_16x16x32_bf16 v[4:7], v[52:55], v[20:23], v[4:7]
ds_read_b128 v[20:23], v0 offset:5120
v_mov_b32 v9, v3
s_waitcnt lgkmcnt(3)
v_mfma_f32_16x16x32_bf16 v[12:15], v[64:67], v[24:27], v[12:15]
v_mfma_f32_16x16x32_bf16 v[4:7], v[68:71], v[24:27], v[4:7]
ds_read_b128 v[24:27], v0 offset:6144
buffer_store_dwordx4 v[8:11], v1, s[16:19], s36 offen sc1
s_waitcnt lgkmcnt(3)
v_mfma_f32_16x16x32_bf16 v[12:15], v[80:83], v[28:31], v[12:15]
s_add_u32 s36, s36, 4096
v_mfma_f32_16x16x32_bf16 v[4:7], v[84:87], v[28:31], v[4:7]
ds_read_b128 v[28:31], v0 offset:7168
s_waitcnt lgkmcnt(3)
v_mfma_f32_16x16x32_bf16 v[12:15], v[96:99], v[16:19], v[12:15]
v_mfma_f32_16x16x32_bf16 v[4:7], v[100:103], v[16:19], v[4:7]
ds_read_b128 v[16:19], v0 offset:8192
s_waitcnt lgkmcnt(3)
v_mfma_f32_16x16x32_bf16 v[12:15], v[112:115], v[20:23], v[12:15]
v_mfma_f32_16x16x32_bf16 v[4:7], v[116:119], v[20:23], v[4:7]
ds_read_b128 v[20:23], v0 offset:9216
s_waitcnt lgkmcnt(3)
v_mfma_f32_16x16x32_bf16 v[12:15], v[128:131], v[24:27], v[12:15]
v_mfma_f32_16x16x32_bf16 v[4:7], v[132:135], v[24:27], v[4:7]
ds_read_b128 v[24:27], v0 offset:10240
s_waitcnt lgkmcnt(3)
v_mfma_f32_16x16x32_bf16 v[12:15], v[144:147], v[28:31], v[12:15]
v_mfma_f32_16x16x32_bf16 v[4:7], v[148:151], v[28:31], v[4:7]
ds_read_b128 v[28:31], v0 offset:11264
s_waitcnt lgkmcnt(3)
s_barrier
v_mfma_f32_16x16x32_bf16 v[12:15], v[160:163], v[16:19], v[12:15]
v_mfma_f32_16x16x32_bf16 v[4:7], v[164:167], v[16:19], v[4:7]
ds_read_b128 v[16:19], v0 offset:12288
s_waitcnt lgkmcnt(3)
v_mfma_f32_16x16x32_bf16 v[12:15], v[176:179], v[20:23], v[12:15]
v_mfma_f32_16x16x32_bf16 v[4:7], v[180:183], v[20:23], v[4:7]
ds_read_b128 v[20:23], v0 offset:13312
v_subrev_u32 v0, s39, v0
s_waitcnt lgkmcnt(3)
v_mfma_f32_16x16x32_bf16 v[12:15], v[192:195], v[24:27], v[12:15]
v_mfma_f32_16x16x32_bf16 v[4:7], v[196:199], v[24:27], v[4:7]
v_add_u32 v1, s40, v1
ds_read_b128 v[24:27], v1 offset:0
s_waitcnt lgkmcnt(3)
v_mfma_f32_16x16x32_bf16 v[12:15], v[208:211], v[28:31], v[12:15]
v_mfma_f32_16x16x32_bf16 v[4:7], v[212:215], v[28:31], v[4:7]
ds_read_b128 v[28:31], v1 offset:1024
s_waitcnt lgkmcnt(3)
v_mfma_f32_16x16x32_bf16 v[12:15], v[224:227], v[16:19], v[12:15]
v_mfma_f32_16x16x32_bf16 v[4:7], v[228:231], v[16:19], v[4:7]
ds_read_b128 v[16:19], v1 offset:2048
s_waitcnt lgkmcnt(3)
v_mfma_f32_16x16x32_bf16 v[12:15], v[240:243], v[20:23], v[12:15]
v_mfma_f32_16x16x32_bf16 v[4:7], v[244:247], v[20:23], v[4:7]
ds_read_b128 v[20:23], v1 offset:3072
s_waitcnt lgkmcnt(3)
v_mfma_f32_16x16x32_bf16 v[12:15], v[40:43], v[24:27], v[12:15]
v_mfma_f32_16x16x32_bf16 v[4:7], v[44:47], v[24:27], v[4:7]
ds_read_b128 v[24:27], v1 offset:4096
s_waitcnt lgkmcnt(3)
v_mfma_f32_16x16x32_bf16 v[12:15], v[56:59], v[28:31], v[12:15]
v_mfma_f32_16x16x32_bf16 v[4:7], v[60:63], v[28:31], v[4:7]
ds_read_b128 v[28:31], v1 offset:5120
s_waitcnt lgkmcnt(3)
v_mfma_f32_16x16x32_bf16 v[12:15], v[72:75], v[16:19], v[12:15]
v_mfma_f32_16x16x32_bf16 v[4:7], v[76:79], v[16:19], v[4:7]
ds_read_b128 v[16:19], v1 offset:6144
s_waitcnt lgkmcnt(3)
v_mfma_f32_16x16x32_bf16 v[12:15], v[88:91], v[20:23], v[12:15]
v_mfma_f32_16x16x32_bf16 v[4:7], v[92:95], v[20:23], v[4:7]
ds_read_b128 v[20:23], v1 offset:7168
s_waitcnt lgkmcnt(3)
v_mfma_f32_16x16x32_bf16 v[12:15], v[104:107], v[24:27], v[12:15]
v_mfma_f32_16x16x32_bf16 v[4:7], v[108:111], v[24:27], v[4:7]
ds_read_b128 v[24:27], v1 offset:8192
s_waitcnt lgkmcnt(3)
v_mfma_f32_16x16x32_bf16 v[12:15], v[120:123], v[28:31], v[12:15]
v_mfma_f32_16x16x32_bf16 v[4:7], v[124:127], v[28:31], v[4:7]
ds_read_b128 v[28:31], v1 offset:9216
s_waitcnt lgkmcnt(3)
v_mfma_f32_16x16x32_bf16 v[12:15], v[136:139], v[16:19], v[12:15]
v_mfma_f32_16x16x32_bf16 v[4:7], v[140:143], v[16:19], v[4:7]
ds_read_b128 v[16:19], v1 offset:10240
s_waitcnt lgkmcnt(3)
v_mfma_f32_16x16x32_bf16 v[12:15], v[152:155], v[20:23], v[12:15]
v_mfma_f32_16x16x32_bf16 v[4:7], v[156:159], v[20:23], v[4:7]
ds_read_b128 v[20:23], v1 offset:11264
s_waitcnt lgkmcnt(3)
v_mfma_f32_16x16x32_bf16 v[12:15], v[168:171], v[24:27], v[12:15]
v_mfma_f32_16x16x32_bf16 v[4:7], v[172:175], v[24:27], v[4:7]
ds_read_b128 v[24:27], v1 offset:12288
s_waitcnt lgkmcnt(3)
v_mfma_f32_16x16x32_bf16 v[12:15], v[184:187], v[28:31], v[12:15]
v_mfma_f32_16x16x32_bf16 v[4:7], v[188:191], v[28:31], v[4:7]
ds_read_b128 v[28:31], v1 offset:13312
v_subrev_u32 v1, s40, v1
s_waitcnt lgkmcnt(3)
v_mfma_f32_16x16x32_bf16 v[12:15], v[200:203], v[16:19], v[12:15]
v_mfma_f32_16x16x32_bf16 v[4:7], v[204:207], v[16:19], v[4:7]
ds_read_b128 v[16:19], v0 offset:8192
s_waitcnt lgkmcnt(3)
v_mfma_f32_16x16x32_bf16 v[12:15], v[216:219], v[20:23], v[12:15]
v_mfma_f32_16x16x32_bf16 v[4:7], v[220:223], v[20:23], v[4:7]
ds_read_b128 v[20:23], v0 offset:9216
s_waitcnt lgkmcnt(3)
v_mfma_f32_16x16x32_bf16 v[12:15], v[232:235], v[24:27], v[12:15]
v_mfma_f32_16x16x32_bf16 v[4:7], v[236:239], v[24:27], v[4:7]
ds_read_b128 v[24:27], v0 offset:10240
s_waitcnt lgkmcnt(3)
v_mfma_f32_16x16x32_bf16 v[12:15], v[248:251], v[28:31], v[12:15]
s_nop 2
v_mfma_f32_16x16x32_bf16 v[4:7], v[252:255], v[28:31], v[4:7]
ds_read_b128 v[28:31], v0 offset:11264
s_waitcnt lgkmcnt(3)
s_nop 0
v_mfma_f32_16x16x32_bf16 v[8:11], v[32:35], v[16:19], 0
v_cvt_pk_bf16_f32 v2, v12, v13
v_cvt_pk_bf16_f32 v3, v14, v15
v_mfma_f32_16x16x32_bf16 v[12:15], v[36:39], v[16:19], 0
ds_read_b128 v[16:19], v0 offset:12288
s_waitcnt lgkmcnt(3)
v_mfma_f32_16x16x32_bf16 v[8:11], v[48:51], v[20:23], v[8:11]
v_cvt_pk_bf16_f32 v7, v6, v7
v_cvt_pk_bf16_f32 v6, v4, v5
v_mov_b32 v4, v2
v_mfma_f32_16x16x32_bf16 v[12:15], v[52:55], v[20:23], v[12:15]
ds_read_b128 v[20:23], v0 offset:13312
v_mov_b32 v5, v3
s_waitcnt lgkmcnt(3)
v_mfma_f32_16x16x32_bf16 v[8:11], v[64:67], v[24:27], v[8:11]
v_mfma_f32_16x16x32_bf16 v[12:15], v[68:71], v[24:27], v[12:15]
ds_read_b128 v[24:27], v0 offset:14336
buffer_store_dwordx4 v[4:7], v1, s[16:19], s36 offen sc1
s_waitcnt lgkmcnt(3)
v_mfma_f32_16x16x32_bf16 v[8:11], v[80:83], v[28:31], v[8:11]
s_add_u32 s36, s36, 4096
v_mfma_f32_16x16x32_bf16 v[12:15], v[84:87], v[28:31], v[12:15]
ds_read_b128 v[28:31], v0 offset:32768
s_waitcnt lgkmcnt(3)
v_mfma_f32_16x16x32_bf16 v[8:11], v[96:99], v[16:19], v[8:11]
v_mfma_f32_16x16x32_bf16 v[12:15], v[100:103], v[16:19], v[12:15]
ds_read_b128 v[16:19], v0 offset:33792
s_waitcnt lgkmcnt(3)
v_mfma_f32_16x16x32_bf16 v[8:11], v[112:115], v[20:23], v[8:11]
v_mfma_f32_16x16x32_bf16 v[12:15], v[116:119], v[20:23], v[12:15]
ds_read_b128 v[20:23], v0 offset:34816
s_waitcnt lgkmcnt(3)
v_mfma_f32_16x16x32_bf16 v[8:11], v[128:131], v[24:27], v[8:11]
v_mfma_f32_16x16x32_bf16 v[12:15], v[132:135], v[24:27], v[12:15]
ds_read_b128 v[24:27], v0 offset:35840
s_waitcnt lgkmcnt(3)
v_mfma_f32_16x16x32_bf16 v[8:11], v[144:147], v[28:31], v[8:11]
v_mfma_f32_16x16x32_bf16 v[12:15], v[148:151], v[28:31], v[12:15]
ds_read_b128 v[28:31], v0 offset:36864
s_waitcnt lgkmcnt(3)
s_barrier
v_mfma_f32_16x16x32_bf16 v[8:11], v[160:163], v[16:19], v[8:11]
v_mfma_f32_16x16x32_bf16 v[12:15], v[164:167], v[16:19], v[12:15]
ds_read_b128 v[16:19], v0 offset:37888
s_waitcnt lgkmcnt(3)
v_mfma_f32_16x16x32_bf16 v[8:11], v[176:179], v[20:23], v[8:11]
v_mfma_f32_16x16x32_bf16 v[12:15], v[180:183], v[20:23], v[12:15]
ds_read_b128 v[20:23], v0 offset:38912
s_waitcnt lgkmcnt(3)
v_mfma_f32_16x16x32_bf16 v[8:11], v[192:195], v[24:27], v[8:11]
v_mfma_f32_16x16x32_bf16 v[12:15], v[196:199], v[24:27], v[12:15]
ds_read_b128 v[24:27], v1 offset:8192
s_waitcnt lgkmcnt(3)
v_mfma_f32_16x16x32_bf16 v[8:11], v[208:211], v[28:31], v[8:11]
v_mfma_f32_16x16x32_bf16 v[12:15], v[212:215], v[28:31], v[12:15]
ds_read_b128 v[28:31], v1 offset:9216
s_waitcnt lgkmcnt(3)
v_mfma_f32_16x16x32_bf16 v[8:11], v[224:227], v[16:19], v[8:11]
v_mfma_f32_16x16x32_bf16 v[12:15], v[228:231], v[16:19], v[12:15]
ds_read_b128 v[16:19], v1 offset:10240
s_waitcnt lgkmcnt(3)
v_mfma_f32_16x16x32_bf16 v[8:11], v[240:243], v[20:23], v[8:11]
v_mfma_f32_16x16x32_bf16 v[12:15], v[244:247], v[20:23], v[12:15]
ds_read_b128 v[20:23], v1 offset:11264
s_waitcnt lgkmcnt(3)
v_mfma_f32_16x16x32_bf16 v[8:11], v[40:43], v[24:27], v[8:11]
v_mfma_f32_16x16x32_bf16 v[12:15], v[44:47], v[24:27], v[12:15]
ds_read_b128 v[24:27], v1 offset:12288
s_waitcnt lgkmcnt(3)
v_mfma_f32_16x16x32_bf16 v[8:11], v[56:59], v[28:31], v[8:11]
v_mfma_f32_16x16x32_bf16 v[12:15], v[60:63], v[28:31], v[12:15]
ds_read_b128 v[28:31], v1 offset:13312
s_waitcnt lgkmcnt(3)
v_mfma_f32_16x16x32_bf16 v[8:11], v[72:75], v[16:19], v[8:11]
v_mfma_f32_16x16x32_bf16 v[12:15], v[76:79], v[16:19], v[12:15]
ds_read_b128 v[16:19], v1 offset:14336
s_waitcnt lgkmcnt(3)
v_mfma_f32_16x16x32_bf16 v[8:11], v[88:91], v[20:23], v[8:11]
v_mfma_f32_16x16x32_bf16 v[12:15], v[92:95], v[20:23], v[12:15]
ds_read_b128 v[20:23], v1 offset:32768
s_waitcnt lgkmcnt(3)
v_mfma_f32_16x16x32_bf16 v[8:11], v[104:107], v[24:27], v[8:11]
v_mfma_f32_16x16x32_bf16 v[12:15], v[108:111], v[24:27], v[12:15]
ds_read_b128 v[24:27], v1 offset:33792
s_waitcnt lgkmcnt(3)
v_mfma_f32_16x16x32_bf16 v[8:11], v[120:123], v[28:31], v[8:11]
v_mfma_f32_16x16x32_bf16 v[12:15], v[124:127], v[28:31], v[12:15]
ds_read_b128 v[28:31], v1 offset:34816
s_waitcnt lgkmcnt(3)
v_mfma_f32_16x16x32_bf16 v[8:11], v[136:139], v[16:19], v[8:11]
v_mfma_f32_16x16x32_bf16 v[12:15], v[140:143], v[16:19], v[12:15]
ds_read_b128 v[16:19], v1 offset:35840
s_waitcnt lgkmcnt(3)
v_mfma_f32_16x16x32_bf16 v[8:11], v[152:155], v[20:23], v[8:11]
v_mfma_f32_16x16x32_bf16 v[12:15], v[156:159], v[20:23], v[12:15]
ds_read_b128 v[20:23], v1 offset:36864
s_waitcnt lgkmcnt(3)
v_mfma_f32_16x16x32_bf16 v[8:11], v[168:171], v[24:27], v[8:11]
v_mfma_f32_16x16x32_bf16 v[12:15], v[172:175], v[24:27], v[12:15]
ds_read_b128 v[24:27], v1 offset:37888
s_waitcnt lgkmcnt(3)
v_mfma_f32_16x16x32_bf16 v[8:11], v[184:187], v[28:31], v[8:11]
v_mfma_f32_16x16x32_bf16 v[12:15], v[188:191], v[28:31], v[12:15]
ds_read_b128 v[28:31], v1 offset:38912
s_waitcnt lgkmcnt(3)
v_mfma_f32_16x16x32_bf16 v[8:11], v[200:203], v[16:19], v[8:11]
v_mfma_f32_16x16x32_bf16 v[12:15], v[204:207], v[16:19], v[12:15]
ds_read_b128 v[16:19], v0 offset:16384
s_waitcnt lgkmcnt(3)
v_mfma_f32_16x16x32_bf16 v[8:11], v[216:219], v[20:23], v[8:11]
v_mfma_f32_16x16x32_bf16 v[12:15], v[220:223], v[20:23], v[12:15]
ds_read_b128 v[20:23], v0 offset:17408
s_waitcnt lgkmcnt(3)
v_mfma_f32_16x16x32_bf16 v[8:11], v[232:235], v[24:27], v[8:11]
v_mfma_f32_16x16x32_bf16 v[12:15], v[236:239], v[24:27], v[12:15]
ds_read_b128 v[24:27], v0 offset:18432
s_waitcnt lgkmcnt(3)
v_mfma_f32_16x16x32_bf16 v[8:11], v[248:251], v[28:31], v[8:11]
s_nop 2
v_mfma_f32_16x16x32_bf16 v[12:15], v[252:255], v[28:31], v[12:15]
ds_read_b128 v[28:31], v0 offset:19456
s_waitcnt lgkmcnt(3)
s_nop 0
v_mfma_f32_16x16x32_bf16 v[4:7], v[32:35], v[16:19], 0
v_cvt_pk_bf16_f32 v2, v8, v9
v_cvt_pk_bf16_f32 v3, v10, v11
v_mfma_f32_16x16x32_bf16 v[8:11], v[36:39], v[16:19], 0
ds_read_b128 v[16:19], v0 offset:20480
s_waitcnt lgkmcnt(3)
v_mfma_f32_16x16x32_bf16 v[4:7], v[48:51], v[20:23], v[4:7]
v_cvt_pk_bf16_f32 v15, v14, v15
v_cvt_pk_bf16_f32 v14, v12, v13
v_min_u32 v12, -2, v2
v_mfma_f32_16x16x32_bf16 v[8:11], v[52:55], v[20:23], v[8:11]
ds_read_b128 v[20:23], v0 offset:21504
v_min_u32 v13, -2, v3
s_waitcnt lgkmcnt(3)
v_mfma_f32_16x16x32_bf16 v[4:7], v[64:67], v[24:27], v[4:7]
v_min_u32 v14, -2, v14
v_min_u32 v15, -2, v15
v_mfma_f32_16x16x32_bf16 v[8:11], v[68:71], v[24:27], v[8:11]
ds_read_b128 v[24:27], v0 offset:22528
buffer_store_dwordx4 v[12:15], v1, s[16:19], s37 offen sc1
s_waitcnt lgkmcnt(3)
v_mfma_f32_16x16x32_bf16 v[4:7], v[80:83], v[28:31], v[4:7]
s_add_u32 s37, s37, 4096
v_mfma_f32_16x16x32_bf16 v[8:11], v[84:87], v[28:31], v[8:11]
ds_read_b128 v[28:31], v0 offset:40960
s_waitcnt lgkmcnt(3)
v_mfma_f32_16x16x32_bf16 v[4:7], v[96:99], v[16:19], v[4:7]
v_mfma_f32_16x16x32_bf16 v[8:11], v[100:103], v[16:19], v[8:11]
ds_read_b128 v[16:19], v0 offset:41984
s_waitcnt lgkmcnt(3)
v_mfma_f32_16x16x32_bf16 v[4:7], v[112:115], v[20:23], v[4:7]
v_mfma_f32_16x16x32_bf16 v[8:11], v[116:119], v[20:23], v[8:11]
ds_read_b128 v[20:23], v0 offset:43008
s_waitcnt vmcnt(1)
buffer_store_dword v1, off, s[16:19], s92 sc1
s_waitcnt lgkmcnt(3)
v_mfma_f32_16x16x32_bf16 v[4:7], v[128:131], v[24:27], v[4:7]
v_mfma_f32_16x16x32_bf16 v[8:11], v[132:135], v[24:27], v[8:11]
ds_read_b128 v[24:27], v0 offset:44032
s_waitcnt lgkmcnt(3)
v_mfma_f32_16x16x32_bf16 v[4:7], v[144:147], v[28:31], v[4:7]
v_mfma_f32_16x16x32_bf16 v[8:11], v[148:151], v[28:31], v[8:11]
ds_read_b128 v[28:31], v0 offset:45056
s_waitcnt lgkmcnt(3)
s_barrier
v_mfma_f32_16x16x32_bf16 v[4:7], v[160:163], v[16:19], v[4:7]
v_mfma_f32_16x16x32_bf16 v[8:11], v[164:167], v[16:19], v[8:11]
ds_read_b128 v[16:19], v0 offset:46080
s_waitcnt lgkmcnt(3)
v_mfma_f32_16x16x32_bf16 v[4:7], v[176:179], v[20:23], v[4:7]
v_mfma_f32_16x16x32_bf16 v[8:11], v[180:183], v[20:23], v[8:11]
ds_read_b128 v[20:23], v0 offset:47104
s_waitcnt lgkmcnt(3)
v_mfma_f32_16x16x32_bf16 v[4:7], v[192:195], v[24:27], v[4:7]
v_mfma_f32_16x16x32_bf16 v[8:11], v[196:199], v[24:27], v[8:11]
ds_read_b128 v[24:27], v1 offset:16384
s_waitcnt lgkmcnt(3)
v_mfma_f32_16x16x32_bf16 v[4:7], v[208:211], v[28:31], v[4:7]
v_mfma_f32_16x16x32_bf16 v[8:11], v[212:215], v[28:31], v[8:11]
ds_read_b128 v[28:31], v1 offset:17408
s_waitcnt lgkmcnt(3)
v_mfma_f32_16x16x32_bf16 v[4:7], v[224:227], v[16:19], v[4:7]
v_mfma_f32_16x16x32_bf16 v[8:11], v[228:231], v[16:19], v[8:11]
ds_read_b128 v[16:19], v1 offset:18432
s_waitcnt lgkmcnt(3)
v_mfma_f32_16x16x32_bf16 v[4:7], v[240:243], v[20:23], v[4:7]
v_mfma_f32_16x16x32_bf16 v[8:11], v[244:247], v[20:23], v[8:11]
ds_read_b128 v[20:23], v1 offset:19456
s_waitcnt lgkmcnt(3)
v_mfma_f32_16x16x32_bf16 v[4:7], v[40:43], v[24:27], v[4:7]
v_mfma_f32_16x16x32_bf16 v[8:11], v[44:47], v[24:27], v[8:11]
ds_read_b128 v[24:27], v1 offset:20480
s_waitcnt lgkmcnt(3)
v_mfma_f32_16x16x32_bf16 v[4:7], v[56:59], v[28:31], v[4:7]
v_mfma_f32_16x16x32_bf16 v[8:11], v[60:63], v[28:31], v[8:11]
ds_read_b128 v[28:31], v1 offset:21504
s_waitcnt lgkmcnt(3)
v_mfma_f32_16x16x32_bf16 v[4:7], v[72:75], v[16:19], v[4:7]
v_mfma_f32_16x16x32_bf16 v[8:11], v[76:79], v[16:19], v[8:11]
ds_read_b128 v[16:19], v1 offset:22528
s_waitcnt lgkmcnt(3)
v_mfma_f32_16x16x32_bf16 v[4:7], v[88:91], v[20:23], v[4:7]
v_mfma_f32_16x16x32_bf16 v[8:11], v[92:95], v[20:23], v[8:11]
ds_read_b128 v[20:23], v1 offset:40960
s_waitcnt lgkmcnt(3)
v_mfma_f32_16x16x32_bf16 v[4:7], v[104:107], v[24:27], v[4:7]
v_mfma_f32_16x16x32_bf16 v[8:11], v[108:111], v[24:27], v[8:11]
ds_read_b128 v[24:27], v1 offset:41984
s_waitcnt lgkmcnt(3)
v_mfma_f32_16x16x32_bf16 v[4:7], v[120:123], v[28:31], v[4:7]
v_mfma_f32_16x16x32_bf16 v[8:11], v[124:127], v[28:31], v[8:11]
ds_read_b128 v[28:31], v1 offset:43008
s_waitcnt lgkmcnt(3)
v_mfma_f32_16x16x32_bf16 v[4:7], v[136:139], v[16:19], v[4:7]
v_mfma_f32_16x16x32_bf16 v[8:11], v[140:143], v[16:19], v[8:11]
ds_read_b128 v[16:19], v1 offset:44032
s_waitcnt lgkmcnt(3)
v_mfma_f32_16x16x32_bf16 v[4:7], v[152:155], v[20:23], v[4:7]
v_mfma_f32_16x16x32_bf16 v[8:11], v[156:159], v[20:23], v[8:11]
ds_read_b128 v[20:23], v1 offset:45056
s_waitcnt lgkmcnt(3)
v_mfma_f32_16x16x32_bf16 v[4:7], v[168:171], v[24:27], v[4:7]
v_mfma_f32_16x16x32_bf16 v[8:11], v[172:175], v[24:27], v[8:11]
ds_read_b128 v[24:27], v1 offset:46080
s_waitcnt lgkmcnt(3)
v_mfma_f32_16x16x32_bf16 v[4:7], v[184:187], v[28:31], v[4:7]
v_mfma_f32_16x16x32_bf16 v[8:11], v[188:191], v[28:31], v[8:11]
ds_read_b128 v[28:31], v1 offset:47104
s_waitcnt lgkmcnt(3)
v_mfma_f32_16x16x32_bf16 v[4:7], v[200:203], v[16:19], v[4:7]
v_mfma_f32_16x16x32_bf16 v[8:11], v[204:207], v[16:19], v[8:11]
ds_read_b128 v[16:19], v0 offset:0
s_waitcnt lgkmcnt(3)
v_mfma_f32_16x16x32_bf16 v[4:7], v[216:219], v[20:23], v[4:7]
v_mfma_f32_16x16x32_bf16 v[8:11], v[220:223], v[20:23], v[8:11]
ds_read_b128 v[20:23], v0 offset:1024
s_waitcnt lgkmcnt(3)
v_mfma_f32_16x16x32_bf16 v[4:7], v[232:235], v[24:27], v[4:7]
v_mfma_f32_16x16x32_bf16 v[8:11], v[236:239], v[24:27], v[8:11]
ds_read_b128 v[24:27], v0 offset:2048
s_waitcnt lgkmcnt(3)
v_mfma_f32_16x16x32_bf16 v[4:7], v[248:251], v[28:31], v[4:7]
s_nop 2
v_mfma_f32_16x16x32_bf16 v[8:11], v[252:255], v[28:31], v[8:11]
ds_read_b128 v[28:31], v0 offset:3072
s_waitcnt lgkmcnt(3)
s_nop 0
v_mfma_f32_16x16x32_bf16 v[12:15], v[32:35], v[16:19], 0
v_cvt_pk_bf16_f32 v2, v4, v5
v_cvt_pk_bf16_f32 v3, v6, v7
v_mfma_f32_16x16x32_bf16 v[4:7], v[36:39], v[16:19], 0
ds_read_b128 v[16:19], v0 offset:4096
s_waitcnt lgkmcnt(3)
v_mfma_f32_16x16x32_bf16 v[12:15], v[48:51], v[20:23], v[12:15]
v_cvt_pk_bf16_f32 v11, v10, v11
v_cvt_pk_bf16_f32 v10, v8, v9
v_min_u32 v8, -2, v2
v_mfma_f32_16x16x32_bf16 v[4:7], v[52:55], v[20:23], v[4:7]
ds_read_b128 v[20:23], v0 offset:5120
v_min_u32 v9, -2, v3
s_waitcnt lgkmcnt(3)
v_mfma_f32_16x16x32_bf16 v[12:15], v[64:67], v[24:27], v[12:15]
v_min_u32 v10, -2, v10
v_min_u32 v11, -2, v11
v_mfma_f32_16x16x32_bf16 v[4:7], v[68:71], v[24:27], v[4:7]
ds_read_b128 v[24:27], v0 offset:6144
buffer_store_dwordx4 v[8:11], v1, s[16:19], s37 offen sc1
s_waitcnt lgkmcnt(3)
v_mfma_f32_16x16x32_bf16 v[12:15], v[80:83], v[28:31], v[12:15]
s_add_u32 s37, s37, 4096
v_mfma_f32_16x16x32_bf16 v[4:7], v[84:87], v[28:31], v[4:7]
ds_read_b128 v[28:31], v0 offset:24576
s_waitcnt lgkmcnt(3)
v_mfma_f32_16x16x32_bf16 v[12:15], v[96:99], v[16:19], v[12:15]
v_mfma_f32_16x16x32_bf16 v[4:7], v[100:103], v[16:19], v[4:7]
ds_read_b128 v[16:19], v0 offset:25600
s_waitcnt lgkmcnt(3)
v_mfma_f32_16x16x32_bf16 v[12:15], v[112:115], v[20:23], v[12:15]
v_mfma_f32_16x16x32_bf16 v[4:7], v[116:119], v[20:23], v[4:7]
ds_read_b128 v[20:23], v0 offset:26624
s_waitcnt lgkmcnt(3)
v_mfma_f32_16x16x32_bf16 v[12:15], v[128:131], v[24:27], v[12:15]
v_mfma_f32_16x16x32_bf16 v[4:7], v[132:135], v[24:27], v[4:7]
ds_read_b128 v[24:27], v0 offset:27648
s_waitcnt lgkmcnt(3)
v_mfma_f32_16x16x32_bf16 v[12:15], v[144:147], v[28:31], v[12:15]
v_mfma_f32_16x16x32_bf16 v[4:7], v[148:151], v[28:31], v[4:7]
ds_read_b128 v[28:31], v0 offset:28672
s_waitcnt lgkmcnt(3)
s_barrier
v_mfma_f32_16x16x32_bf16 v[12:15], v[160:163], v[16:19], v[12:15]
v_mfma_f32_16x16x32_bf16 v[4:7], v[164:167], v[16:19], v[4:7]
ds_read_b128 v[16:19], v0 offset:29696
s_waitcnt lgkmcnt(3)
v_mfma_f32_16x16x32_bf16 v[12:15], v[176:179], v[20:23], v[12:15]
v_mfma_f32_16x16x32_bf16 v[4:7], v[180:183], v[20:23], v[4:7]
ds_read_b128 v[20:23], v0 offset:30720
s_waitcnt lgkmcnt(3)
v_mfma_f32_16x16x32_bf16 v[12:15], v[192:195], v[24:27], v[12:15]
v_mfma_f32_16x16x32_bf16 v[4:7], v[196:199], v[24:27], v[4:7]
ds_read_b128 v[24:27], v1 offset:0
s_waitcnt lgkmcnt(3)
v_mfma_f32_16x16x32_bf16 v[12:15], v[208:211], v[28:31], v[12:15]
v_mfma_f32_16x16x32_bf16 v[4:7], v[212:215], v[28:31], v[4:7]
ds_read_b128 v[28:31], v1 offset:1024
s_waitcnt lgkmcnt(3)
v_mfma_f32_16x16x32_bf16 v[12:15], v[224:227], v[16:19], v[12:15]
v_mfma_f32_16x16x32_bf16 v[4:7], v[228:231], v[16:19], v[4:7]
ds_read_b128 v[16:19], v1 offset:2048
s_waitcnt lgkmcnt(3)
v_mfma_f32_16x16x32_bf16 v[12:15], v[240:243], v[20:23], v[12:15]
v_mfma_f32_16x16x32_bf16 v[4:7], v[244:247], v[20:23], v[4:7]
ds_read_b128 v[20:23], v1 offset:3072
s_waitcnt lgkmcnt(3)
v_mfma_f32_16x16x32_bf16 v[12:15], v[40:43], v[24:27], v[12:15]
v_mfma_f32_16x16x32_bf16 v[4:7], v[44:47], v[24:27], v[4:7]
ds_read_b128 v[24:27], v1 offset:4096
s_waitcnt lgkmcnt(3)
v_mfma_f32_16x16x32_bf16 v[12:15], v[56:59], v[28:31], v[12:15]
v_mfma_f32_16x16x32_bf16 v[4:7], v[60:63], v[28:31], v[4:7]
ds_read_b128 v[28:31], v1 offset:5120
s_waitcnt lgkmcnt(3)
v_mfma_f32_16x16x32_bf16 v[12:15], v[72:75], v[16:19], v[12:15]
v_mfma_f32_16x16x32_bf16 v[4:7], v[76:79], v[16:19], v[4:7]
ds_read_b128 v[16:19], v1 offset:6144
s_waitcnt lgkmcnt(3)
v_mfma_f32_16x16x32_bf16 v[12:15], v[88:91], v[20:23], v[12:15]
v_mfma_f32_16x16x32_bf16 v[4:7], v[92:95], v[20:23], v[4:7]
ds_read_b128 v[20:23], v1 offset:24576
s_waitcnt lgkmcnt(3)
v_mfma_f32_16x16x32_bf16 v[12:15], v[104:107], v[24:27], v[12:15]
v_mfma_f32_16x16x32_bf16 v[4:7], v[108:111], v[24:27], v[4:7]
ds_read_b128 v[24:27], v1 offset:25600
s_waitcnt lgkmcnt(3)
v_mfma_f32_16x16x32_bf16 v[12:15], v[120:123], v[28:31], v[12:15]
v_mfma_f32_16x16x32_bf16 v[4:7], v[124:127], v[28:31], v[4:7]
ds_read_b128 v[28:31], v1 offset:26624
s_waitcnt lgkmcnt(3)
v_mfma_f32_16x16x32_bf16 v[12:15], v[136:139], v[16:19], v[12:15]
v_mfma_f32_16x16x32_bf16 v[4:7], v[140:143], v[16:19], v[4:7]
ds_read_b128 v[16:19], v1 offset:27648
s_waitcnt lgkmcnt(3)
v_mfma_f32_16x16x32_bf16 v[12:15], v[152:155], v[20:23], v[12:15]
v_mfma_f32_16x16x32_bf16 v[4:7], v[156:159], v[20:23], v[4:7]
ds_read_b128 v[20:23], v1 offset:28672
s_waitcnt lgkmcnt(3)
v_mfma_f32_16x16x32_bf16 v[12:15], v[168:171], v[24:27], v[12:15]
v_mfma_f32_16x16x32_bf16 v[4:7], v[172:175], v[24:27], v[4:7]
ds_read_b128 v[24:27], v1 offset:29696
s_waitcnt lgkmcnt(3)
v_mfma_f32_16x16x32_bf16 v[12:15], v[184:187], v[28:31], v[12:15]
v_mfma_f32_16x16x32_bf16 v[4:7], v[188:191], v[28:31], v[4:7]
ds_read_b128 v[28:31], v1 offset:30720
s_waitcnt lgkmcnt(3)
v_mfma_f32_16x16x32_bf16 v[12:15], v[200:203], v[16:19], v[12:15]
v_mfma_f32_16x16x32_bf16 v[4:7], v[204:207], v[16:19], v[4:7]
v_add_u32 v0, s39, v0
ds_read_b128 v[16:19], v0 offset:0
s_waitcnt lgkmcnt(3)
v_mfma_f32_16x16x32_bf16 v[12:15], v[216:219], v[20:23], v[12:15]
v_mfma_f32_16x16x32_bf16 v[4:7], v[220:223], v[20:23], v[4:7]
ds_read_b128 v[20:23], v0 offset:1024
s_waitcnt lgkmcnt(3)
v_mfma_f32_16x16x32_bf16 v[12:15], v[232:235], v[24:27], v[12:15]
v_mfma_f32_16x16x32_bf16 v[4:7], v[236:239], v[24:27], v[4:7]
ds_read_b128 v[24:27], v0 offset:2048
s_waitcnt lgkmcnt(3)
v_mfma_f32_16x16x32_bf16 v[12:15], v[248:251], v[28:31], v[12:15]
s_nop 2
v_mfma_f32_16x16x32_bf16 v[4:7], v[252:255], v[28:31], v[4:7]
ds_read_b128 v[28:31], v0 offset:3072
s_waitcnt lgkmcnt(3)
s_nop 0
v_mfma_f32_16x16x32_bf16 v[8:11], v[32:35], v[16:19], 0
v_cvt_pk_bf16_f32 v2, v12, v13
v_cvt_pk_bf16_f32 v3, v14, v15
v_mfma_f32_16x16x32_bf16 v[12:15], v[36:39], v[16:19], 0
ds_read_b128 v[16:19], v0 offset:4096
s_waitcnt lgkmcnt(3)
v_mfma_f32_16x16x32_bf16 v[8:11], v[48:51], v[20:23], v[8:11]
v_cvt_pk_bf16_f32 v7, v6, v7
v_cvt_pk_bf16_f32 v6, v4, v5
v_min_u32 v4, -2, v2
v_mfma_f32_16x16x32_bf16 v[12:15], v[52:55], v[20:23], v[12:15]
ds_read_b128 v[20:23], v0 offset:5120
v_min_u32 v5, -2, v3
s_waitcnt lgkmcnt(3)
v_mfma_f32_16x16x32_bf16 v[8:11], v[64:67], v[24:27], v[8:11]
v_min_u32 v6, -2, v6
v_min_u32 v7, -2, v7
v_mfma_f32_16x16x32_bf16 v[12:15], v[68:71], v[24:27], v[12:15]
ds_read_b128 v[24:27], v0 offset:6144
buffer_store_dwordx4 v[4:7], v1, s[16:19], s38 offen sc1
s_waitcnt lgkmcnt(3)
v_mfma_f32_16x16x32_bf16 v[8:11], v[80:83], v[28:31], v[8:11]
s_add_u32 s38, s38, 4096
v_mfma_f32_16x16x32_bf16 v[12:15], v[84:87], v[28:31], v[12:15]
ds_read_b128 v[28:31], v0 offset:7168
s_waitcnt lgkmcnt(3)
v_mfma_f32_16x16x32_bf16 v[8:11], v[96:99], v[16:19], v[8:11]
v_mfma_f32_16x16x32_bf16 v[12:15], v[100:103], v[16:19], v[12:15]
ds_read_b128 v[16:19], v0 offset:8192
s_waitcnt lgkmcnt(3)
v_mfma_f32_16x16x32_bf16 v[8:11], v[112:115], v[20:23], v[8:11]
v_mfma_f32_16x16x32_bf16 v[12:15], v[116:119], v[20:23], v[12:15]
ds_read_b128 v[20:23], v0 offset:9216
s_waitcnt lgkmcnt(3)
v_mfma_f32_16x16x32_bf16 v[8:11], v[128:131], v[24:27], v[8:11]
v_mfma_f32_16x16x32_bf16 v[12:15], v[132:135], v[24:27], v[12:15]
ds_read_b128 v[24:27], v0 offset:10240
s_waitcnt lgkmcnt(3)
v_mfma_f32_16x16x32_bf16 v[8:11], v[144:147], v[28:31], v[8:11]
v_mfma_f32_16x16x32_bf16 v[12:15], v[148:151], v[28:31], v[12:15]
ds_read_b128 v[28:31], v0 offset:11264
s_waitcnt lgkmcnt(3)
s_barrier
v_mfma_f32_16x16x32_bf16 v[8:11], v[160:163], v[16:19], v[8:11]
v_mfma_f32_16x16x32_bf16 v[12:15], v[164:167], v[16:19], v[12:15]
ds_read_b128 v[16:19], v0 offset:12288
s_waitcnt lgkmcnt(3)
v_mfma_f32_16x16x32_bf16 v[8:11], v[176:179], v[20:23], v[8:11]
v_mfma_f32_16x16x32_bf16 v[12:15], v[180:183], v[20:23], v[12:15]
ds_read_b128 v[20:23], v0 offset:13312
v_subrev_u32 v0, s39, v0
s_waitcnt lgkmcnt(3)
v_mfma_f32_16x16x32_bf16 v[8:11], v[192:195], v[24:27], v[8:11]
v_mfma_f32_16x16x32_bf16 v[12:15], v[196:199], v[24:27], v[12:15]
v_add_u32 v1, s40, v1
ds_read_b128 v[24:27], v1 offset:0
s_waitcnt lgkmcnt(3)
v_mfma_f32_16x16x32_bf16 v[8:11], v[208:211], v[28:31], v[8:11]
v_mfma_f32_16x16x32_bf16 v[12:15], v[212:215], v[28:31], v[12:15]
ds_read_b128 v[28:31], v1 offset:1024
s_waitcnt lgkmcnt(3)
v_mfma_f32_16x16x32_bf16 v[8:11], v[224:227], v[16:19], v[8:11]
v_mfma_f32_16x16x32_bf16 v[12:15], v[228:231], v[16:19], v[12:15]
ds_read_b128 v[16:19], v1 offset:2048
s_waitcnt lgkmcnt(3)
v_mfma_f32_16x16x32_bf16 v[8:11], v[240:243], v[20:23], v[8:11]
v_mfma_f32_16x16x32_bf16 v[12:15], v[244:247], v[20:23], v[12:15]
ds_read_b128 v[20:23], v1 offset:3072
s_waitcnt lgkmcnt(3)
v_mfma_f32_16x16x32_bf16 v[8:11], v[40:43], v[24:27], v[8:11]
v_mfma_f32_16x16x32_bf16 v[12:15], v[44:47], v[24:27], v[12:15]
ds_read_b128 v[24:27], v1 offset:4096
s_waitcnt lgkmcnt(3)
v_mfma_f32_16x16x32_bf16 v[8:11], v[56:59], v[28:31], v[8:11]
v_mfma_f32_16x16x32_bf16 v[12:15], v[60:63], v[28:31], v[12:15]
ds_read_b128 v[28:31], v1 offset:5120
s_waitcnt lgkmcnt(3)
v_mfma_f32_16x16x32_bf16 v[8:11], v[72:75], v[16:19], v[8:11]
v_mfma_f32_16x16x32_bf16 v[12:15], v[76:79], v[16:19], v[12:15]
ds_read_b128 v[16:19], v1 offset:6144
s_waitcnt lgkmcnt(3)
v_mfma_f32_16x16x32_bf16 v[8:11], v[88:91], v[20:23], v[8:11]
v_mfma_f32_16x16x32_bf16 v[12:15], v[92:95], v[20:23], v[12:15]
ds_read_b128 v[20:23], v1 offset:7168
s_waitcnt lgkmcnt(3)
v_mfma_f32_16x16x32_bf16 v[8:11], v[104:107], v[24:27], v[8:11]
v_mfma_f32_16x16x32_bf16 v[12:15], v[108:111], v[24:27], v[12:15]
ds_read_b128 v[24:27], v1 offset:8192
s_waitcnt lgkmcnt(3)
v_mfma_f32_16x16x32_bf16 v[8:11], v[120:123], v[28:31], v[8:11]
v_mfma_f32_16x16x32_bf16 v[12:15], v[124:127], v[28:31], v[12:15]
ds_read_b128 v[28:31], v1 offset:9216
s_waitcnt lgkmcnt(3)
v_mfma_f32_16x16x32_bf16 v[8:11], v[136:139], v[16:19], v[8:11]
v_mfma_f32_16x16x32_bf16 v[12:15], v[140:143], v[16:19], v[12:15]
ds_read_b128 v[16:19], v1 offset:10240
s_waitcnt lgkmcnt(3)
v_mfma_f32_16x16x32_bf16 v[8:11], v[152:155], v[20:23], v[8:11]
v_mfma_f32_16x16x32_bf16 v[12:15], v[156:159], v[20:23], v[12:15]
ds_read_b128 v[20:23], v1 offset:11264
s_waitcnt lgkmcnt(3)
v_mfma_f32_16x16x32_bf16 v[8:11], v[168:171], v[24:27], v[8:11]
v_mfma_f32_16x16x32_bf16 v[12:15], v[172:175], v[24:27], v[12:15]
ds_read_b128 v[24:27], v1 offset:12288
s_waitcnt lgkmcnt(3)
v_mfma_f32_16x16x32_bf16 v[8:11], v[184:187], v[28:31], v[8:11]
v_mfma_f32_16x16x32_bf16 v[12:15], v[188:191], v[28:31], v[12:15]
ds_read_b128 v[28:31], v1 offset:13312
v_subrev_u32 v1, s40, v1
s_waitcnt lgkmcnt(3)
v_mfma_f32_16x16x32_bf16 v[8:11], v[200:203], v[16:19], v[8:11]
v_mfma_f32_16x16x32_bf16 v[12:15], v[204:207], v[16:19], v[12:15]
ds_read_b128 v[16:19], v0 offset:8192
s_waitcnt lgkmcnt(3)
v_mfma_f32_16x16x32_bf16 v[8:11], v[216:219], v[20:23], v[8:11]
v_mfma_f32_16x16x32_bf16 v[12:15], v[220:223], v[20:23], v[12:15]
ds_read_b128 v[20:23], v0 offset:9216
s_waitcnt lgkmcnt(3)
v_mfma_f32_16x16x32_bf16 v[8:11], v[232:235], v[24:27], v[8:11]
v_mfma_f32_16x16x32_bf16 v[12:15], v[236:239], v[24:27], v[12:15]
ds_read_b128 v[24:27], v0 offset:10240
s_waitcnt lgkmcnt(3)
v_mfma_f32_16x16x32_bf16 v[8:11], v[248:251], v[28:31], v[8:11]
s_nop 2
v_mfma_f32_16x16x32_bf16 v[12:15], v[252:255], v[28:31], v[12:15]
ds_read_b128 v[28:31], v0 offset:11264
s_waitcnt lgkmcnt(3)
s_nop 0
v_mfma_f32_16x16x32_bf16 v[4:7], v[32:35], v[16:19], 0
v_cvt_pk_bf16_f32 v2, v8, v9
v_cvt_pk_bf16_f32 v3, v10, v11
v_mfma_f32_16x16x32_bf16 v[8:11], v[36:39], v[16:19], 0
ds_read_b128 v[16:19], v0 offset:12288
s_waitcnt lgkmcnt(3)
v_mfma_f32_16x16x32_bf16 v[4:7], v[48:51], v[20:23], v[4:7]
v_cvt_pk_bf16_f32 v15, v14, v15
v_cvt_pk_bf16_f32 v14, v12, v13
v_min_u32 v12, -2, v2
v_mfma_f32_16x16x32_bf16 v[8:11], v[52:55], v[20:23], v[8:11]
ds_read_b128 v[20:23], v0 offset:13312
v_min_u32 v13, -2, v3
s_waitcnt lgkmcnt(3)
v_mfma_f32_16x16x32_bf16 v[4:7], v[64:67], v[24:27], v[4:7]
v_min_u32 v14, -2, v14
v_min_u32 v15, -2, v15
v_mfma_f32_16x16x32_bf16 v[8:11], v[68:71], v[24:27], v[8:11]
ds_read_b128 v[24:27], v0 offset:14336
buffer_store_dwordx4 v[12:15], v1, s[16:19], s38 offen sc1
s_waitcnt lgkmcnt(3)
v_mfma_f32_16x16x32_bf16 v[4:7], v[80:83], v[28:31], v[4:7]
s_add_u32 s38, s38, 4096
v_mfma_f32_16x16x32_bf16 v[8:11], v[84:87], v[28:31], v[8:11]
ds_read_b128 v[28:31], v0 offset:32768
s_waitcnt lgkmcnt(3)
v_mfma_f32_16x16x32_bf16 v[4:7], v[96:99], v[16:19], v[4:7]
v_mfma_f32_16x16x32_bf16 v[8:11], v[100:103], v[16:19], v[8:11]
ds_read_b128 v[16:19], v0 offset:33792
s_waitcnt lgkmcnt(3)
v_mfma_f32_16x16x32_bf16 v[4:7], v[112:115], v[20:23], v[4:7]
v_add_u32 v2, s41, v1
v_mfma_f32_16x16x32_bf16 v[8:11], v[116:119], v[20:23], v[8:11]
ds_read_b128 v[20:23], v0 offset:34816
s_waitcnt lgkmcnt(3)
v_mfma_f32_16x16x32_bf16 v[4:7], v[128:131], v[24:27], v[4:7]
v_mfma_f32_16x16x32_bf16 v[8:11], v[132:135], v[24:27], v[8:11]
ds_read_b128 v[24:27], v0 offset:35840
s_waitcnt lgkmcnt(3)
v_mfma_f32_16x16x32_bf16 v[4:7], v[144:147], v[28:31], v[4:7]
v_mfma_f32_16x16x32_bf16 v[8:11], v[148:151], v[28:31], v[8:11]
ds_read_b128 v[28:31], v0 offset:36864
s_waitcnt lgkmcnt(3)
s_barrier
v_mfma_f32_16x16x32_bf16 v[4:7], v[160:163], v[16:19], v[4:7]
v_mfma_f32_16x16x32_bf16 v[8:11], v[164:167], v[16:19], v[8:11]
ds_read_b128 v[16:19], v0 offset:37888
s_waitcnt lgkmcnt(3)
v_mfma_f32_16x16x32_bf16 v[4:7], v[176:179], v[20:23], v[4:7]
v_mfma_f32_16x16x32_bf16 v[8:11], v[180:183], v[20:23], v[8:11]
ds_read_b128 v[20:23], v0 offset:38912
s_waitcnt lgkmcnt(3)
v_mfma_f32_16x16x32_bf16 v[4:7], v[192:195], v[24:27], v[4:7]
v_mfma_f32_16x16x32_bf16 v[8:11], v[196:199], v[24:27], v[8:11]
ds_read_b128 v[24:27], v1 offset:8192
s_waitcnt lgkmcnt(3)
v_mfma_f32_16x16x32_bf16 v[4:7], v[208:211], v[28:31], v[4:7]
v_mfma_f32_16x16x32_bf16 v[8:11], v[212:215], v[28:31], v[8:11]
ds_read_b128 v[28:31], v1 offset:9216
s_waitcnt lgkmcnt(3)
v_mfma_f32_16x16x32_bf16 v[4:7], v[224:227], v[16:19], v[4:7]
v_mfma_f32_16x16x32_bf16 v[8:11], v[228:231], v[16:19], v[8:11]
ds_read_b128 v[16:19], v1 offset:10240
s_waitcnt lgkmcnt(3)
v_mfma_f32_16x16x32_bf16 v[4:7], v[240:243], v[20:23], v[4:7]
v_mfma_f32_16x16x32_bf16 v[8:11], v[244:247], v[20:23], v[8:11]
ds_read_b128 v[20:23], v1 offset:11264
s_waitcnt lgkmcnt(3)
v_mfma_f32_16x16x32_bf16 v[4:7], v[40:43], v[24:27], v[4:7]
v_mfma_f32_16x16x32_bf16 v[8:11], v[44:47], v[24:27], v[8:11]
ds_read_b128 v[24:27], v1 offset:12288
s_waitcnt lgkmcnt(3)
v_mfma_f32_16x16x32_bf16 v[4:7], v[56:59], v[28:31], v[4:7]
v_mfma_f32_16x16x32_bf16 v[8:11], v[60:63], v[28:31], v[8:11]
ds_read_b128 v[28:31], v1 offset:13312
s_waitcnt lgkmcnt(3)
v_mfma_f32_16x16x32_bf16 v[4:7], v[72:75], v[16:19], v[4:7]
v_mfma_f32_16x16x32_bf16 v[8:11], v[76:79], v[16:19], v[8:11]
ds_read_b128 v[16:19], v1 offset:14336
s_waitcnt lgkmcnt(3)
v_mfma_f32_16x16x32_bf16 v[4:7], v[88:91], v[20:23], v[4:7]
v_mfma_f32_16x16x32_bf16 v[8:11], v[92:95], v[20:23], v[8:11]
ds_read_b128 v[20:23], v1 offset:32768
s_waitcnt lgkmcnt(3)
v_mfma_f32_16x16x32_bf16 v[4:7], v[104:107], v[24:27], v[4:7]
v_mfma_f32_16x16x32_bf16 v[8:11], v[108:111], v[24:27], v[8:11]
ds_read_b128 v[24:27], v1 offset:33792
s_waitcnt lgkmcnt(3)
v_mfma_f32_16x16x32_bf16 v[4:7], v[120:123], v[28:31], v[4:7]
v_mfma_f32_16x16x32_bf16 v[8:11], v[124:127], v[28:31], v[8:11]
ds_read_b128 v[28:31], v1 offset:34816
s_waitcnt lgkmcnt(3)
v_mfma_f32_16x16x32_bf16 v[4:7], v[136:139], v[16:19], v[4:7]
v_mfma_f32_16x16x32_bf16 v[8:11], v[140:143], v[16:19], v[8:11]
ds_read_b128 v[16:19], v1 offset:35840
s_waitcnt lgkmcnt(3)
v_mfma_f32_16x16x32_bf16 v[4:7], v[152:155], v[20:23], v[4:7]
v_mfma_f32_16x16x32_bf16 v[8:11], v[156:159], v[20:23], v[8:11]
ds_read_b128 v[20:23], v1 offset:36864
s_waitcnt lgkmcnt(3)
v_mfma_f32_16x16x32_bf16 v[4:7], v[168:171], v[24:27], v[4:7]
v_mfma_f32_16x16x32_bf16 v[8:11], v[172:175], v[24:27], v[8:11]
ds_read_b128 v[24:27], v1 offset:37888
s_waitcnt lgkmcnt(3)
v_mfma_f32_16x16x32_bf16 v[4:7], v[184:187], v[28:31], v[4:7]
v_mfma_f32_16x16x32_bf16 v[8:11], v[188:191], v[28:31], v[8:11]
ds_read_b128 v[28:31], v1 offset:38912
s_waitcnt lgkmcnt(3)
v_mfma_f32_16x16x32_bf16 v[4:7], v[200:203], v[16:19], v[4:7]
v_mfma_f32_16x16x32_bf16 v[8:11], v[204:207], v[16:19], v[8:11]
ds_read_b128 v[16:19], v0 offset:16384
s_waitcnt lgkmcnt(3)
v_mfma_f32_16x16x32_bf16 v[4:7], v[216:219], v[20:23], v[4:7]
v_mfma_f32_16x16x32_bf16 v[8:11], v[220:223], v[20:23], v[8:11]
ds_read_b128 v[20:23], v0 offset:17408
s_waitcnt lgkmcnt(3)
v_mfma_f32_16x16x32_bf16 v[4:7], v[232:235], v[24:27], v[4:7]
v_mfma_f32_16x16x32_bf16 v[8:11], v[236:239], v[24:27], v[8:11]
ds_read_b128 v[24:27], v0 offset:18432
s_waitcnt lgkmcnt(3)
v_mfma_f32_16x16x32_bf16 v[4:7], v[248:251], v[28:31], v[4:7]
s_nop 2
v_mfma_f32_16x16x32_bf16 v[8:11], v[252:255], v[28:31], v[8:11]
ds_read_b128 v[28:31], v0 offset:19456
s_waitcnt lgkmcnt(3)
s_nop 0
v_mfma_f32_16x16x32_bf16 v[12:15], v[32:35], v[16:19], 0
ds_write_b128 v2, v[4:7] offset:0
v_mfma_f32_16x16x32_bf16 v[4:7], v[36:39], v[16:19], 0
ds_read_b128 v[16:19], v0 offset:20480
s_waitcnt lgkmcnt(4)
v_mfma_f32_16x16x32_bf16 v[12:15], v[48:51], v[20:23], v[12:15]
ds_write_b128 v2, v[8:11] offset:1024
v_mfma_f32_16x16x32_bf16 v[4:7], v[52:55], v[20:23], v[4:7]
ds_read_b128 v[20:23], v0 offset:21504
s_waitcnt lgkmcnt(5)
v_mfma_f32_16x16x32_bf16 v[12:15], v[64:67], v[24:27], v[12:15]
v_mfma_f32_16x16x32_bf16 v[4:7], v[68:71], v[24:27], v[4:7]
ds_read_b128 v[24:27], v0 offset:22528
s_waitcnt lgkmcnt(5)
v_mfma_f32_16x16x32_bf16 v[12:15], v[80:83], v[28:31], v[12:15]
v_mfma_f32_16x16x32_bf16 v[4:7], v[84:87], v[28:31], v[4:7]
ds_read_b128 v[28:31], v0 offset:40960
s_waitcnt lgkmcnt(4)
v_mfma_f32_16x16x32_bf16 v[12:15], v[96:99], v[16:19], v[12:15]
v_mfma_f32_16x16x32_bf16 v[4:7], v[100:103], v[16:19], v[4:7]
ds_read_b128 v[16:19], v0 offset:41984
s_waitcnt lgkmcnt(3)
v_mfma_f32_16x16x32_bf16 v[12:15], v[112:115], v[20:23], v[12:15]
v_mfma_f32_16x16x32_bf16 v[4:7], v[116:119], v[20:23], v[4:7]
ds_read_b128 v[20:23], v0 offset:43008
s_waitcnt lgkmcnt(3)
s_barrier
v_mfma_f32_16x16x32_bf16 v[12:15], v[128:131], v[24:27], v[12:15]
v_mfma_f32_16x16x32_bf16 v[4:7], v[132:135], v[24:27], v[4:7]
ds_read_b128 v[24:27], v0 offset:44032
s_waitcnt lgkmcnt(3)
v_mfma_f32_16x16x32_bf16 v[12:15], v[144:147], v[28:31], v[12:15]
v_mfma_f32_16x16x32_bf16 v[4:7], v[148:151], v[28:31], v[4:7]
ds_read_b128 v[28:31], v0 offset:45056
s_waitcnt lgkmcnt(3)
v_mfma_f32_16x16x32_bf16 v[12:15], v[160:163], v[16:19], v[12:15]
v_mfma_f32_16x16x32_bf16 v[4:7], v[164:167], v[16:19], v[4:7]
ds_read_b128 v[16:19], v0 offset:46080
s_waitcnt lgkmcnt(3)
v_mfma_f32_16x16x32_bf16 v[12:15], v[176:179], v[20:23], v[12:15]
v_mfma_f32_16x16x32_bf16 v[4:7], v[180:183], v[20:23], v[4:7]
ds_read_b128 v[20:23], v0 offset:47104
s_waitcnt lgkmcnt(3)
v_mfma_f32_16x16x32_bf16 v[12:15], v[192:195], v[24:27], v[12:15]
v_mfma_f32_16x16x32_bf16 v[4:7], v[196:199], v[24:27], v[4:7]
ds_read_b128 v[24:27], v1 offset:16384
s_waitcnt lgkmcnt(3)
v_mfma_f32_16x16x32_bf16 v[12:15], v[208:211], v[28:31], v[12:15]
v_mfma_f32_16x16x32_bf16 v[4:7], v[212:215], v[28:31], v[4:7]
ds_read_b128 v[28:31], v1 offset:17408
s_waitcnt lgkmcnt(3)
v_mfma_f32_16x16x32_bf16 v[12:15], v[224:227], v[16:19], v[12:15]
v_mfma_f32_16x16x32_bf16 v[4:7], v[228:231], v[16:19], v[4:7]
ds_read_b128 v[16:19], v1 offset:18432
s_waitcnt lgkmcnt(3)
v_mfma_f32_16x16x32_bf16 v[12:15], v[240:243], v[20:23], v[12:15]
v_mfma_f32_16x16x32_bf16 v[4:7], v[244:247], v[20:23], v[4:7]
ds_read_b128 v[20:23], v1 offset:19456
s_waitcnt lgkmcnt(3)
v_mfma_f32_16x16x32_bf16 v[12:15], v[40:43], v[24:27], v[12:15]
v_mfma_f32_16x16x32_bf16 v[4:7], v[44:47], v[24:27], v[4:7]
ds_read_b128 v[24:27], v1 offset:20480
s_waitcnt lgkmcnt(3)
v_mfma_f32_16x16x32_bf16 v[12:15], v[56:59], v[28:31], v[12:15]
v_mfma_f32_16x16x32_bf16 v[4:7], v[60:63], v[28:31], v[4:7]
ds_read_b128 v[28:31], v1 offset:21504
s_waitcnt lgkmcnt(3)
v_mfma_f32_16x16x32_bf16 v[12:15], v[72:75], v[16:19], v[12:15]
v_mfma_f32_16x16x32_bf16 v[4:7], v[76:79], v[16:19], v[4:7]
ds_read_b128 v[16:19], v1 offset:22528
s_waitcnt lgkmcnt(3)
v_mfma_f32_16x16x32_bf16 v[12:15], v[88:91], v[20:23], v[12:15]
v_mfma_f32_16x16x32_bf16 v[4:7], v[92:95], v[20:23], v[4:7]
ds_read_b128 v[20:23], v1 offset:40960
s_waitcnt lgkmcnt(3)
v_mfma_f32_16x16x32_bf16 v[12:15], v[104:107], v[24:27], v[12:15]
v_mfma_f32_16x16x32_bf16 v[4:7], v[108:111], v[24:27], v[4:7]
ds_read_b128 v[24:27], v1 offset:41984
s_waitcnt lgkmcnt(3)
v_mfma_f32_16x16x32_bf16 v[12:15], v[120:123], v[28:31], v[12:15]
v_mfma_f32_16x16x32_bf16 v[4:7], v[124:127], v[28:31], v[4:7]
ds_read_b128 v[28:31], v1 offset:43008
s_waitcnt lgkmcnt(3)
v_mfma_f32_16x16x32_bf16 v[12:15], v[136:139], v[16:19], v[12:15]
v_mfma_f32_16x16x32_bf16 v[4:7], v[140:143], v[16:19], v[4:7]
ds_read_b128 v[16:19], v1 offset:44032
s_waitcnt lgkmcnt(3)
v_mfma_f32_16x16x32_bf16 v[12:15], v[152:155], v[20:23], v[12:15]
v_mfma_f32_16x16x32_bf16 v[4:7], v[156:159], v[20:23], v[4:7]
ds_read_b128 v[20:23], v1 offset:45056
s_waitcnt lgkmcnt(3)
v_mfma_f32_16x16x32_bf16 v[12:15], v[168:171], v[24:27], v[12:15]
v_mfma_f32_16x16x32_bf16 v[4:7], v[172:175], v[24:27], v[4:7]
ds_read_b128 v[24:27], v1 offset:46080
s_waitcnt lgkmcnt(3)
v_mfma_f32_16x16x32_bf16 v[12:15], v[184:187], v[28:31], v[12:15]
v_mfma_f32_16x16x32_bf16 v[4:7], v[188:191], v[28:31], v[4:7]
ds_read_b128 v[28:31], v1 offset:47104
s_waitcnt lgkmcnt(3)
v_mfma_f32_16x16x32_bf16 v[12:15], v[200:203], v[16:19], v[12:15]
v_mfma_f32_16x16x32_bf16 v[4:7], v[204:207], v[16:19], v[4:7]
s_waitcnt lgkmcnt(2)
v_mfma_f32_16x16x32_bf16 v[12:15], v[216:219], v[20:23], v[12:15]
v_mfma_f32_16x16x32_bf16 v[4:7], v[220:223], v[20:23], v[4:7]
s_waitcnt lgkmcnt(1)
v_mfma_f32_16x16x32_bf16 v[12:15], v[232:235], v[24:27], v[12:15]
v_mfma_f32_16x16x32_bf16 v[4:7], v[236:239], v[24:27], v[4:7]
s_waitcnt lgkmcnt(0)
v_mfma_f32_16x16x32_bf16 v[12:15], v[248:251], v[28:31], v[12:15]
s_nop 2
v_mfma_f32_16x16x32_bf16 v[4:7], v[252:255], v[28:31], v[4:7]
s_nop 3
ds_write_b128 v2, v[12:15] offset:8192
s_nop 2
ds_write_b128 v2, v[4:7] offset:9216
s_waitcnt lgkmcnt(0)
s_barrier
s_endpgm
L_lidle:
s_mul_i32 s54, s33, 24576
s_add_u32 s54, s54, 49152
v_lshlrev_b32 v28, 11, v1
s_lshr_b32 s24, s30, 3
s_and_b32 s35, s29, 1
s_lshl_b32 s35, s35, 2
s_add_u32 s24, s24, s35
s_and_b32 s27, s30, 7
s_xor_b32 s27, s27, s35
s_lshl_b32 s26, s24, 3
s_add_u32 s26, s26, s27
s_lshl_b32 s26, s26, 2
s_lshl_b32 s97, s24, 2
s_add_u32 s97, s97, s25
s_lshl_b32 s97, s97, 7
s_add_u32 s97, s97, 25165824
s_mul_i32 s100, s24, 917504
s_mul_i32 s35, s25, 28672
s_add_u32 s100, s100, s35
s_mov_b32 s16, s48
s_and_b32 s17, s49, 0xffff
s_mov_b32 s18, 268435456
s_mov_b32 s19, 0x20000
v_lshlrev_b32 v12, 4, v0
v_lshlrev_b32 v29, 1, v3
v_xor_b32 v29, v29, v2
v_lshl_add_u32 v29, v29, 4, v28
v_add_u32 v16, 0, v29
v_add_u32 v17, 15360, v29
v_add_u32 v18, 30720, v29
v_add_u32 v19, 46080, v29
s_mul_i32 s58, s25, 896
s_lshr_b32 s35, s33, 1
s_mul_i32 s59, s35, 448
s_add_u32 s58, s58, s59
s_lshl_b32 s58, s58, 11
s_lshl_b32 s59, s27, 8
s_add_u32 s58, s58, s59
s_and_b32 s59, s33, 1
s_lshl_b32 s53, s59, 7
s_add_u32 s58, s58, s53
v_lshrrev_b32 v29, 2, v0
v_and_b32 v30, 3, v0
v_lshlrev_b32 v30, 3, v30
v_lshl_add_u32 v30, v29, 7, v30
v_and_b32 v29, 3, v1
s_and_b32 s53, s33, 2
v_xor_b32 v29, s53, v29
v_lshl_add_u32 v20, v29, 5, v30
v_xor_b32 v21, 32, v20
s_lshl_b32 s59, s33, 12
s_xor_b32 s45, s59, 0x2000
s_mul_i32 s44, s45, 6
s_add_u32 s44, s44, 49152
s_and_b32 s53, s33, 1
s_mul_i32 s53, s53, 15360
s_lshl_b32 s52, s35, 6
s_add_u32 s53, s53, s52
s_add_u32 s53, s53, 147456
v_mov_b32 v22, s53
v_xor_b32 v23, 64, v22
s_mul_i32 s53, s35, 49152
s_add_u32 s52, s53, 49152
v_add_u32 v0, s52, v12
s_sub_u32 s52, 98304, s53
v_add_u32 v1, s52, v12
s_mul_i32 s53, s35, 99328
s_add_u32 s39, s53, -49152
s_sub_u32 s40, 50176, s53
s_lshl_b32 s41, s33, 11
s_add_u32 s41, s41, 32768
s_sub_u32 s41, s41, s52
s_lshl_b32 s53, s33, 10
s_sub_u32 s53, s53, s52
s_add_u32 s36, s25, 1
s_and_b32 s36, s36, 3
s_add_u32 s36, s36, s26
s_lshl_b32 s92, s36, 2
s_add_u32 s92, s92, s33
s_lshl_b32 s92, s92, 7
s_add_u32 s92, s92, 25231360
s_mul_i32 s36, s36, 24576
s_add_u32 s36, s36, s53
s_add_u32 s36, s36, 8388608
s_add_u32 s37, s25, 2
s_and_b32 s37, s37, 3
s_add_u32 s37, s37, s26
s_mul_i32 s37, s37, 24576
s_add_u32 s37, s37, s53
s_add_u32 s37, s37, 8396800
s_add_u32 s38, s25, 3
s_and_b32 s38, s38, 3
s_add_u32 s38, s38, s26
s_mul_i32 s38, s38, 24576
s_add_u32 s38, s38, s53
s_add_u32 s38, s38, 8404992
s_mov_b32 s51, 32768
s_mov_b32 s24, s42
s_and_b32 s25, s43, 0xffff
s_mov_b32 s26, 7340032
s_mov_b32 s27, 0x20000
v_mov_b32 v29, 0
s_mov_b64 exec, 1
ds_write_b32 v22, v29
s_mov_b64 exec, -1
s_waitcnt lgkmcnt(0)
s_barrier
s_add_u32 m0, s54, 8192
s_nop 0
buffer_load_dwordx4 v16, s[24:27], s58 offen offset:0 lds
buffer_load_dwordx4 v17, s[24:27], s58 offen offset:1024 lds
buffer_load_dwordx4 v18, s[24:27], s58 offen offset:2048 lds
buffer_load_dwordx4 v19, s[24:27], s58 offen offset:3072 lds
s_add_u32 s58, s58, 65536
s_add_u32 m0, s54, 12288
s_nop 0
buffer_load_dwordx4 v16, s[24:27], s58 offen offset:0 lds
buffer_load_dwordx4 v17, s[24:27], s58 offen offset:1024 lds
buffer_load_dwordx4 v18, s[24:27], s58 offen offset:2048 lds
buffer_load_dwordx4 v19, s[24:27], s58 offen offset:3072 lds
s_add_u32 s58, s58, 65536
s_add_u32 m0, s59, 16384
s_nop 0
buffer_load_dwordx4 v16, s[24:27], s58 offen offset:0 lds
buffer_load_dwordx4 v17, s[24:27], s58 offen offset:1024 lds
buffer_load_dwordx4 v18, s[24:27], s58 offen offset:2048 lds
buffer_load_dwordx4 v19, s[24:27], s58 offen offset:3072 lds
s_add_u32 s58, s58, 65536
s_add_u32 m0, s54, 16384
s_nop 0
buffer_load_dwordx4 v16, s[24:27], s58 offen offset:0 lds
buffer_load_dwordx4 v17, s[24:27], s58 offen offset:1024 lds
buffer_load_dwordx4 v18, s[24:27], s58 offen offset:2048 lds
buffer_load_dwordx4 v19, s[24:27], s58 offen offset:3072 lds
s_add_u32 s58, s58, 65536
s_add_u32 m0, s54, 20480
s_nop 0
buffer_load_dwordx4 v16, s[24:27], s58 offen offset:0 lds
buffer_load_dwordx4 v17, s[24:27], s58 offen offset:1024 lds
buffer_load_dwordx4 v18, s[24:27], s58 offen offset:2048 lds
buffer_load_dwordx4 v19, s[24:27], s58 offen offset:3072 lds
s_add_u32 s58, s58, 65536
s_add_u32 m0, s59, 32768
s_nop 0
buffer_load_dwordx4 v16, s[24:27], s58 offen offset:0 lds
buffer_load_dwordx4 v17, s[24:27], s58 offen offset:1024 lds
buffer_load_dwordx4 v18, s[24:27], s58 offen offset:2048 lds
buffer_load_dwordx4 v19, s[24:27], s58 offen offset:3072 lds
s_add_u32 s58, s58, 65536
s_add_u32 s53, s54, 0
s_add_u32 s52, s44, 0
v_add_u32 v4, s53, v20
v_add_u32 v6, s52, v20
v_add_u32 v5, s53, v21
v_add_u32 v7, s52, v21
s_add_u32 s53, s59, 0
s_add_u32 s52, s45, 0
v_add_u32 v8, s53, v20
v_add_u32 v10, s52, v20
v_add_u32 v9, s53, v21
v_add_u32 v11, s52, v21
s_waitcnt vmcnt(16)
v_mov_b32 v29, 1
s_mov_b64 exec, 1
ds_write_b32 v22, v29
s_mov_b64 exec, -1
ds_read_b64_tr_b16 v[32:33], v4 offset:8192
ds_read_b64_tr_b16 v[34:35], v4 offset:10240
ds_read_b64_tr_b16 v[36:37], v5 offset:8192
ds_read_b64_tr_b16 v[38:39], v5 offset:10240
ds_read_b64_tr_b16 v[48:49], v4 offset:12288
ds_read_b64_tr_b16 v[50:51], v4 offset:14336
ds_read_b64_tr_b16 v[52:53], v5 offset:12288
ds_read_b64_tr_b16 v[54:55], v5 offset:14336
L_pw0_0:
ds_read_b32 v30, v23
s_waitcnt lgkmcnt(0)
v_cmp_gt_u32 vcc, 1, v30
s_cbranch_vccnz L_pw0_0
ds_read_b64_tr_b16 v[40:41], v6 offset:8192
ds_read_b64_tr_b16 v[42:43], v6 offset:10240
ds_read_b64_tr_b16 v[44:45], v7 offset:8192
ds_read_b64_tr_b16 v[46:47], v7 offset:10240
ds_read_b64_tr_b16 v[56:57], v6 offset:12288
ds_read_b64_tr_b16 v[58:59], v6 offset:14336
ds_read_b64_tr_b16 v[60:61], v7 offset:12288
ds_read_b64_tr_b16 v[62:63], v7 offset:14336
s_waitcnt vmcnt(8)
v_mov_b32 v29, 2
s_mov_b64 exec, 1
ds_write_b32 v22, v29
s_mov_b64 exec, -1
ds_read_b64_tr_b16 v[64:65], v8 offset:16384
ds_read_b64_tr_b16 v[66:67], v8 offset:18432
ds_read_b64_tr_b16 v[68:69], v9 offset:16384
ds_read_b64_tr_b16 v[70:71], v9 offset:18432
ds_read_b64_tr_b16 v[80:81], v4 offset:16384
ds_read_b64_tr_b16 v[82:83], v4 offset:18432
ds_read_b64_tr_b16 v[84:85], v5 offset:16384
ds_read_b64_tr_b16 v[86:87], v5 offset:18432
L_pw0_1:
ds_read_b32 v30, v23
s_waitcnt lgkmcnt(0)
v_cmp_gt_u32 vcc, 2, v30
s_cbranch_vccnz L_pw0_1
s_add_u32 m0, s54, 8192
s_nop 0
buffer_load_dwordx4 v16, s[24:27], s58 offen offset:0 lds
buffer_load_dwordx4 v17, s[24:27], s58 offen offset:1024 lds
buffer_load_dwordx4 v18, s[24:27], s58 offen offset:2048 lds
buffer_load_dwordx4 v19, s[24:27], s58 offen offset:3072 lds
s_add_u32 s58, s58, 65536
ds_read_b64_tr_b16 v[72:73], v10 offset:16384
ds_read_b64_tr_b16 v[74:75], v10 offset:18432
ds_read_b64_tr_b16 v[76:77], v11 offset:16384
ds_read_b64_tr_b16 v[78:79], v11 offset:18432
s_add_u32 m0, s54, 12288
s_nop 0
buffer_load_dwordx4 v16, s[24:27], s58 offen offset:0 lds
buffer_load_dwordx4 v17, s[24:27], s58 offen offset:1024 lds
buffer_load_dwordx4 v18, s[24:27], s58 offen offset:2048 lds
buffer_load_dwordx4 v19, s[24:27], s58 offen offset:3072 lds
s_add_u32 s58, s58, 65536
ds_read_b64_tr_b16 v[88:89], v6 offset:16384
ds_read_b64_tr_b16 v[90:91], v6 offset:18432
ds_read_b64_tr_b16 v[92:93], v7 offset:16384
ds_read_b64_tr_b16 v[94:95], v7 offset:18432
s_waitcnt vmcnt(8)
v_mov_b32 v29, 3
s_mov_b64 exec, 1
ds_write_b32 v22, v29
s_mov_b64 exec, -1
ds_read_b64_tr_b16 v[96:97], v4 offset:20480
ds_read_b64_tr_b16 v[98:99], v4 offset:22528
ds_read_b64_tr_b16 v[100:101], v5 offset:20480
ds_read_b64_tr_b16 v[102:103], v5 offset:22528
ds_read_b64_tr_b16 v[112:113], v8 offset:32768
ds_read_b64_tr_b16 v[114:115], v8 offset:34816
ds_read_b64_tr_b16 v[116:117], v9 offset:32768
ds_read_b64_tr_b16 v[118:119], v9 offset:34816
L_pw0_2:
ds_read_b32 v30, v23
s_waitcnt lgkmcnt(0)
v_cmp_gt_u32 vcc, 3, v30
s_cbranch_vccnz L_pw0_2
s_add_u32 m0, s59, 16384
s_nop 0
buffer_load_dwordx4 v16, s[24:27], s58 offen offset:0 lds
buffer_load_dwordx4 v17, s[24:27], s58 offen offset:1024 lds
buffer_load_dwordx4 v18, s[24:27], s58 offen offset:2048 lds
buffer_load_dwordx4 v19, s[24:27], s58 offen offset:3072 lds
s_add_u32 s58, s58, 65536
ds_read_b64_tr_b16 v[104:105], v6 offset:20480
ds_read_b64_tr_b16 v[106:107], v6 offset:22528
ds_read_b64_tr_b16 v[108:109], v7 offset:20480
ds_read_b64_tr_b16 v[110:111], v7 offset:22528
s_add_u32 m0, s54, 16384
s_nop 0
buffer_load_dwordx4 v16, s[24:27], s58 offen offset:0 lds
buffer_load_dwordx4 v17, s[24:27], s58 offen offset:1024 lds
buffer_load_dwordx4 v18, s[24:27], s58 offen offset:2048 lds
buffer_load_dwordx4 v19, s[24:27], s58 offen offset:3072 lds
s_add_u32 s58, s58, 65536
ds_read_b64_tr_b16 v[120:121], v10 offset:32768
ds_read_b64_tr_b16 v[122:123], v10 offset:34816
ds_read_b64_tr_b16 v[124:125], v11 offset:32768
ds_read_b64_tr_b16 v[126:127], v11 offset:34816
s_barrier
s_waitcnt vmcnt(8)
v_mov_b32 v29, 4
s_mov_b64 exec, 1
ds_write_b32 v22, v29
s_mov_b64 exec, -1
ds_read_b64_tr_b16 v[128:129], v4 offset:8192
ds_read_b64_tr_b16 v[130:131], v4 offset:10240
ds_read_b64_tr_b16 v[132:133], v5 offset:8192
ds_read_b64_tr_b16 v[134:135], v5 offset:10240
ds_read_b64_tr_b16 v[144:145], v4 offset:12288
ds_read_b64_tr_b16 v[146:147], v4 offset:14336
ds_read_b64_tr_b16 v[148:149], v5 offset:12288
ds_read_b64_tr_b16 v[150:151], v5 offset:14336
L_pw0_3:
ds_read_b32 v30, v23
s_waitcnt lgkmcnt(0)
v_cmp_gt_u32 vcc, 4, v30
s_cbranch_vccnz L_pw0_3
s_add_u32 m0, s54, 20480
s_nop 0
buffer_load_dwordx4 v16, s[24:27], s58 offen offset:0 lds
buffer_load_dwordx4 v17, s[24:27], s58 offen offset:1024 lds
buffer_load_dwordx4 v18, s[24:27], s58 offen offset:2048 lds
buffer_load_dwordx4 v19, s[24:27], s58 offen offset:3072 lds
s_add_u32 s58, s58, 65536
ds_read_b64_tr_b16 v[136:137], v6 offset:8192
ds_read_b64_tr_b16 v[138:139], v6 offset:10240
ds_read_b64_tr_b16 v[140:141], v7 offset:8192
ds_read_b64_tr_b16 v[142:143], v7 offset:10240
s_add_u32 m0, s59, 32768
s_nop 0
buffer_load_dwordx4 v16, s[24:27], s58 offen offset:0 lds
buffer_load_dwordx4 v17, s[24:27], s58 offen offset:1024 lds
buffer_load_dwordx4 v18, s[24:27], s58 offen offset:2048 lds
buffer_load_dwordx4 v19, s[24:27], s58 offen offset:3072 lds
s_add_u32 s58, s58, 65536
ds_read_b64_tr_b16 v[152:153], v6 offset:12288
ds_read_b64_tr_b16 v[154:155], v6 offset:14336
ds_read_b64_tr_b16 v[156:157], v7 offset:12288
ds_read_b64_tr_b16 v[158:159], v7 offset:14336
s_waitcnt vmcnt(8)
v_mov_b32 v29, 5
s_mov_b64 exec, 1
ds_write_b32 v22, v29
s_mov_b64 exec, -1
ds_read_b64_tr_b16 v[160:161], v8 offset:16384
ds_read_b64_tr_b16 v[162:163], v8 offset:18432
ds_read_b64_tr_b16 v[164:165], v9 offset:16384
ds_read_b64_tr_b16 v[166:167], v9 offset:18432
ds_read_b64_tr_b16 v[176:177], v4 offset:16384
ds_read_b64_tr_b16 v[178:179], v4 offset:18432
ds_read_b64_tr_b16 v[180:181], v5 offset:16384
ds_read_b64_tr_b16 v[182:183], v5 offset:18432
L_pw0_4:
ds_read_b32 v30, v23
s_waitcnt lgkmcnt(0)
v_cmp_gt_u32 vcc, 5, v30
s_cbranch_vccnz L_pw0_4
s_add_u32 m0, s54, 8192
s_nop 0
buffer_load_dwordx4 v16, s[24:27], s58 offen offset:0 lds
buffer_load_dwordx4 v17, s[24:27], s58 offen offset:1024 lds
buffer_load_dwordx4 v18, s[24:27], s58 offen offset:2048 lds
buffer_load_dwordx4 v19, s[24:27], s58 offen offset:3072 lds
s_add_u32 s58, s58, 65536
ds_read_b64_tr_b16 v[168:169], v10 offset:16384
ds_read_b64_tr_b16 v[170:171], v10 offset:18432
ds_read_b64_tr_b16 v[172:173], v11 offset:16384
ds_read_b64_tr_b16 v[174:175], v11 offset:18432
s_add_u32 m0, s54, 12288
s_nop 0
buffer_load_dwordx4 v16, s[24:27], s58 offen offset:0 lds
buffer_load_dwordx4 v17, s[24:27], s58 offen offset:1024 lds
buffer_load_dwordx4 v18, s[24:27], s58 offen offset:2048 lds
buffer_load_dwordx4 v19, s[24:27], s58 offen offset:3072 lds
s_add_u32 s58, s58, 65536
ds_read_b64_tr_b16 v[184:185], v6 offset:16384
ds_read_b64_tr_b16 v[186:187], v6 offset:18432
ds_read_b64_tr_b16 v[188:189], v7 offset:16384
ds_read_b64_tr_b16 v[190:191], v7 offset:18432
s_waitcnt vmcnt(8)
v_mov_b32 v29, 6
s_mov_b64 exec, 1
ds_write_b32 v22, v29
s_mov_b64 exec, -1
ds_read_b64_tr_b16 v[192:193], v4 offset:20480
ds_read_b64_tr_b16 v[194:195], v4 offset:22528
ds_read_b64_tr_b16 v[196:197], v5 offset:20480
ds_read_b64_tr_b16 v[198:199], v5 offset:22528
ds_read_b64_tr_b16 v[208:209], v8 offset:32768
ds_read_b64_tr_b16 v[210:211], v8 offset:34816
ds_read_b64_tr_b16 v[212:213], v9 offset:32768
ds_read_b64_tr_b16 v[214:215], v9 offset:34816
L_pw0_5:
ds_read_b32 v30, v23
s_waitcnt lgkmcnt(0)
v_cmp_gt_u32 vcc, 6, v30
s_cbranch_vccnz L_pw0_5
ds_read_b64_tr_b16 v[200:201], v6 offset:20480
ds_read_b64_tr_b16 v[202:203], v6 offset:22528
ds_read_b64_tr_b16 v[204:205], v7 offset:20480
ds_read_b64_tr_b16 v[206:207], v7 offset:22528
ds_read_b64_tr_b16 v[216:217], v10 offset:32768
ds_read_b64_tr_b16 v[218:219], v10 offset:34816
ds_read_b64_tr_b16 v[220:221], v11 offset:32768
ds_read_b64_tr_b16 v[222:223], v11 offset:34816
s_waitcnt vmcnt(0)
v_mov_b32 v29, 7
s_mov_b64 exec, 1
ds_write_b32 v22, v29
s_mov_b64 exec, -1
ds_read_b64_tr_b16 v[224:225], v4 offset:8192
ds_read_b64_tr_b16 v[226:227], v4 offset:10240
ds_read_b64_tr_b16 v[228:229], v5 offset:8192
ds_read_b64_tr_b16 v[230:231], v5 offset:10240
ds_read_b64_tr_b16 v[240:241], v4 offset:12288
ds_read_b64_tr_b16 v[242:243], v4 offset:14336
ds_read_b64_tr_b16 v[244:245], v5 offset:12288
ds_read_b64_tr_b16 v[246:247], v5 offset:14336
L_pw0_6:
ds_read_b32 v30, v23
s_waitcnt lgkmcnt(0)
v_cmp_gt_u32 vcc, 7, v30
s_cbranch_vccnz L_pw0_6
ds_read_b64_tr_b16 v[232:233], v6 offset:8192
ds_read_b64_tr_b16 v[234:235], v6 offset:10240
ds_read_b64_tr_b16 v[236:237], v7 offset:8192
ds_read_b64_tr_b16 v[238:239], v7 offset:10240
ds_read_b64_tr_b16 v[248:249], v6 offset:12288
ds_read_b64_tr_b16 v[250:251], v6 offset:14336
ds_read_b64_tr_b16 v[252:253], v7 offset:12288
ds_read_b64_tr_b16 v[254:255], v7 offset:14336
s_branch L_hpoll
L_comp:
s_lshr_b32 s24, s30, 3
s_and_b32 s35, s29, 1
s_lshl_b32 s35, s35, 2
s_add_u32 s24, s24, s35
s_and_b32 s27, s30, 7
s_xor_b32 s27, s27, s35
s_lshl_b32 s26, s24, 3
s_add_u32 s26, s26, s27
s_lshl_b32 s26, s26, 2
s_lshl_b32 s97, s24, 2
s_add_u32 s97, s97, s25
s_lshl_b32 s97, s97, 7
s_add_u32 s97, s97, 25165824
s_mul_i32 s100, s24, 917504
s_mul_i32 s35, s25, 28672
s_add_u32 s100, s100, s35
v_lshrrev_b32 v1, 4, v0
v_bfe_u32 v2, v0, 2, 2
v_lshl_add_u32 v2, v1, 3, v2
v_lshlrev_b32 v2, 7, v2
v_and_b32 v3, 3, v0
v_lshl_add_u32 v2, v3, 3, v2
v_bfe_u32 v3, v0, 3, 2
v_xor_b32 v15, 0, v3
v_lshl_add_u32 v4, v15, 5, v2
v_xor_b32 v15, 1, v3
v_lshl_add_u32 v5, v15, 5, v2
v_xor_b32 v15, 2, v3
v_lshl_add_u32 v6, v15, 5, v2
v_xor_b32 v15, 3, v3
v_lshl_add_u32 v7, v15, 5, v2
s_mul_i32 s34, s28, 24576
s_add_u32 s34, s34, 49152
v_and_b32 v12, 15, v0
v_lshlrev_b32 v10, 7, v12
v_add_u32 v10, s34, v10
v_bfe_u32 v13, v0, 1, 3
v_xor_b32 v13, v13, v1
v_lshl_add_u32 v8, v13, 4, v10
v_xor_b32 v9, 64, v8
v_and_b32 v2, 1, v1
v_lshlrev_b32 v13, 11, v12
v_lshl_add_u32 v13, v2, 5, v13
v_lshrrev_b32 v2, 1, v1
v_lshl_add_u32 v13, v2, 4, v13
s_and_b32 s33, s28, 1
v_lshlrev_b32 v12, 4, v0
s_lshl_b32 s35, s28, 11
s_add_u32 s35, s35, 32768
v_add_u32 v11, s35, v12
v_and_b32 v116, 31, v0
v_lshlrev_b32 v116, 2, v116
s_lshl_b32 s35, s29, 2
v_mov_b32 v14, s35
v_mov_b32 v3, 0x80
v_bfrev_b32 v1, 1
v_cmp_eq_u32 vcc, 0, v0
v_cndmask_b32 v3, v3, v14, vcc
v_cndmask_b32 v1, v1, v0, vcc
s_getreg_b32 s35, hwreg(HW_REG_XCC_ID, 0, 4)
s_mul_i32 s52, s35, s35
s_lshl_b32 s52, s52, 18
s_lshl_b32 s35, s35, 8
s_add_u32 s35, s35, s52
s_add_u32 s35, s35, 1
v_mov_b32 v15, s35
s_lshl_b32 s58, s35, 5
s_add_u32 s23, s26, s25
s_lshl_b32 s22, s23, 2
s_add_u32 s22, s22, s28
s_lshl_b32 s22, s22, 7
s_add_u32 s22, s22, 25231360
s_mul_i32 s23, s23, 24
s_add_u32 s23, s23, s28
s_lshl_b32 s23, s23, 10
s_add_u32 s23, s23, 8388608
s_lshl_b32 s57, s24, 3
s_add_u32 s57, s57, s25
s_lshl_b32 s57, s57, 15
s_lshl_b32 s35, s27, 8
s_add_u32 s57, s57, s35
s_lshl_b32 s35, s33, 7
s_add_u32 s57, s57, s35
s_and_b32 s35, s28, 2
s_lshl_b32 s35, s35, 5
s_add_u32 s57, s57, s35
s_lshl_b32 s34, s31, 2
s_add_u32 s34, s34, s28
s_lshr_b32 s96, s34, 1
s_lshl_b32 s96, s96, 2
s_add_u32 s96, s96, s25
s_lshl_b32 s96, s96, 1
s_add_u32 s96, s96, s33
s_lshl_b32 s96, s96, 4
s_add_u32 s96, s96, s99
s_lshl_b32 s96, s96, 2
s_add_u32 s96, s96, 25165824
s_mul_i32 s34, s34, 458752
s_lshl_b32 s35, s32, 11
s_add_u32 s34, s34, s35
s_cmp_eq_u32 s28, 0
s_cselect_b32 s33, 13, -1
s_mov_b32 s59, 32768
s_waitcnt lgkmcnt(0)
s_mov_b32 s16, s48
s_and_b32 s17, s49, 0xffff
s_mov_b32 s18, 268435456
s_mov_b32 s19, 0x20000
s_mov_b32 s4, s44
s_and_b32 s5, s45, 0xffff
s_mov_b32 s6, 2097152
s_mov_b32 s7, 0x20000
s_mov_b32 s8, s46
s_and_b32 s9, s47, 0xffff
s_mov_b32 s10, 256
s_mov_b32 s11, 0x20000
s_mov_b32 s84, s38
s_and_b32 s85, s39, 0xffff
s_mov_b32 s86, 7340032
s_mov_b32 s87, 0x20000
s_mov_b32 s12, s40
s_and_b32 s13, s41, 0xffff
s_mov_b32 s14, 7340032
s_mov_b32 s15, 0x20000
s_mul_i32 s38, s28, 7168
s_add_u32 s36, s38, s100
s_cmp_ge_u32 s28, 2
s_cselect_b32 s37, 134144, 0
s_add_u32 s38, s38, s37
s_mul_i32 s37, s28, 24576
s_add_u32 s37, s37, 49152
s_cmp_ge_u32 s30, 28
s_cbranch_scc1 L_cidle
v_mov_b32 v128, 0
v_mov_b32 v129, 0
v_mov_b32 v130, 0
v_mov_b32 v131, 0
v_mov_b32 v132, 0
v_mov_b32 v133, 0
v_mov_b32 v134, 0
v_mov_b32 v135, 0
v_mov_b32 v136, 0
v_mov_b32 v137, 0
v_mov_b32 v138, 0
v_mov_b32 v139, 0
v_mov_b32 v140, 0
v_mov_b32 v141, 0
v_mov_b32 v142, 0
v_mov_b32 v143, 0
v_mov_b32 v144, 0
v_mov_b32 v145, 0
v_mov_b32 v146, 0
v_mov_b32 v147, 0
v_mov_b32 v148, 0
v_mov_b32 v149, 0
v_mov_b32 v150, 0
v_mov_b32 v151, 0
v_mov_b32 v152, 0
v_mov_b32 v153, 0
v_mov_b32 v154, 0
v_mov_b32 v155, 0
v_mov_b32 v156, 0
v_mov_b32 v157, 0
v_mov_b32 v158, 0
v_mov_b32 v159, 0
v_mov_b32 v160, 0
v_mov_b32 v161, 0
v_mov_b32 v162, 0
v_mov_b32 v163, 0
v_mov_b32 v164, 0
v_mov_b32 v165, 0
v_mov_b32 v166, 0
v_mov_b32 v167, 0
v_mov_b32 v168, 0
v_mov_b32 v169, 0
v_mov_b32 v170, 0
v_mov_b32 v171, 0
v_mov_b32 v172, 0
v_mov_b32 v173, 0
v_mov_b32 v174, 0
v_mov_b32 v175, 0
v_mov_b32 v176, 0
v_mov_b32 v177, 0
v_mov_b32 v178, 0
v_mov_b32 v179, 0
v_mov_b32 v180, 0
v_mov_b32 v181, 0
v_mov_b32 v182, 0
v_mov_b32 v183, 0
v_mov_b32 v184, 0
v_mov_b32 v185, 0
v_mov_b32 v186, 0
v_mov_b32 v187, 0
v_mov_b32 v188, 0
v_mov_b32 v189, 0
v_mov_b32 v190, 0
v_mov_b32 v191, 0
v_mov_b32 v192, 0
v_mov_b32 v193, 0
v_mov_b32 v194, 0
v_mov_b32 v195, 0
v_mov_b32 v196, 0
v_mov_b32 v197, 0
v_mov_b32 v198, 0
v_mov_b32 v199, 0
v_mov_b32 v200, 0
v_mov_b32 v201, 0
v_mov_b32 v202, 0
v_mov_b32 v203, 0
v_mov_b32 v204, 0
v_mov_b32 v205, 0
v_mov_b32 v206, 0
v_mov_b32 v207, 0
v_mov_b32 v208, 0
v_mov_b32 v209, 0
v_mov_b32 v210, 0
v_mov_b32 v211, 0
v_mov_b32 v212, 0
v_mov_b32 v213, 0
v_mov_b32 v214, 0
v_mov_b32 v215, 0
v_mov_b32 v216, 0
v_mov_b32 v217, 0
v_mov_b32 v218, 0
v_mov_b32 v219, 0
v_mov_b32 v220, 0
v_mov_b32 v221, 0
v_mov_b32 v222, 0
v_mov_b32 v223, 0
v_mov_b32 v224, 0
v_mov_b32 v225, 0
v_mov_b32 v226, 0
v_mov_b32 v227, 0
v_mov_b32 v228, 0
v_mov_b32 v229, 0
v_mov_b32 v230, 0
v_mov_b32 v231, 0
v_mov_b32 v232, 0
v_mov_b32 v233, 0
v_mov_b32 v234, 0
v_mov_b32 v235, 0
v_mov_b32 v236, 0
v_mov_b32 v237, 0
v_mov_b32 v238, 0
v_mov_b32 v239, 0
v_mov_b32 v240, 0
v_mov_b32 v241, 0
v_mov_b32 v242, 0
v_mov_b32 v243, 0
v_mov_b32 v244, 0
v_mov_b32 v245, 0
v_mov_b32 v246, 0
v_mov_b32 v247, 0
v_mov_b32 v248, 0
v_mov_b32 v249, 0
v_mov_b32 v250, 0
v_mov_b32 v251, 0
v_mov_b32 v252, 0
v_mov_b32 v253, 0
v_mov_b32 v254, 0
v_mov_b32 v255, 0
s_mov_b32 s50, 0
s_mov_b32 s51, 15
s_barrier
ds_read_b64_tr_b16 v[16:17], v4 offset:0
ds_read_b64_tr_b16 v[18:19], v4 offset:512
ds_read_b128 v[80:83], v8 offset:0
ds_read_b128 v[84:87], v8 offset:2048
ds_read_b128 v[88:91], v8 offset:4096
ds_read_b128 v[92:95], v8 offset:6144
ds_read_b64_tr_b16 v[20:21], v5 offset:0
ds_read_b64_tr_b16 v[22:23], v5 offset:512
ds_read_b64_tr_b16 v[24:25], v6 offset:0
ds_read_b64_tr_b16 v[26:27], v6 offset:512
ds_read_b64_tr_b16 v[28:29], v7 offset:0
ds_read_b64_tr_b16 v[30:31], v7 offset:512
ds_read_b64_tr_b16 v[32:33], v4 offset:8192
ds_read_b64_tr_b16 v[34:35], v4 offset:8704
ds_read_b64_tr_b16 v[36:37], v5 offset:8192
ds_read_b64_tr_b16 v[38:39], v5 offset:8704
ds_read_b64_tr_b16 v[40:41], v6 offset:8192
ds_read_b64_tr_b16 v[42:43], v6 offset:8704
ds_read_b64_tr_b16 v[44:45], v7 offset:8192
ds_read_b64_tr_b16 v[46:47], v7 offset:8704
s_waitcnt lgkmcnt(0)
L_cloop:
v_mfma_f32_16x16x32_bf16 v[128:131], v[16:19], v[80:83], v[128:131]
ds_read_b64_tr_b16 v[48:49], v4 offset:4096
v_mfma_f32_16x16x32_bf16 v[144:147], v[16:19], v[84:87], v[144:147]
ds_read_b64_tr_b16 v[50:51], v4 offset:4608
v_mfma_f32_16x16x32_bf16 v[160:163], v[16:19], v[88:91], v[160:163]
ds_read_b128 v[96:99], v9 offset:0
v_mfma_f32_16x16x32_bf16 v[176:179], v[16:19], v[92:95], v[176:179]
ds_read_b128 v[100:103], v9 offset:2048
v_mfma_f32_16x16x32_bf16 v[180:183], v[20:23], v[92:95], v[180:183]
ds_read_b128 v[104:107], v9 offset:4096
v_mfma_f32_16x16x32_bf16 v[164:167], v[20:23], v[88:91], v[164:167]
ds_read_b128 v[108:111], v9 offset:6144
v_mfma_f32_16x16x32_bf16 v[148:151], v[20:23], v[84:87], v[148:151]
ds_read_b64_tr_b16 v[52:53], v5 offset:4096
v_mfma_f32_16x16x32_bf16 v[132:135], v[20:23], v[80:83], v[132:135]
ds_read_b64_tr_b16 v[54:55], v5 offset:4608
v_mfma_f32_16x16x32_bf16 v[136:139], v[24:27], v[80:83], v[136:139]
ds_read_b64_tr_b16 v[56:57], v6 offset:4096
v_mfma_f32_16x16x32_bf16 v[152:155], v[24:27], v[84:87], v[152:155]
ds_read_b64_tr_b16 v[58:59], v6 offset:4608
v_mfma_f32_16x16x32_bf16 v[168:171], v[24:27], v[88:91], v[168:171]
ds_read_b64_tr_b16 v[60:61], v7 offset:4096
v_mfma_f32_16x16x32_bf16 v[184:187], v[24:27], v[92:95], v[184:187]
ds_read_b64_tr_b16 v[62:63], v7 offset:4608
v_mfma_f32_16x16x32_bf16 v[188:191], v[28:31], v[92:95], v[188:191]
ds_read_b64_tr_b16 v[64:65], v4 offset:12288
v_mfma_f32_16x16x32_bf16 v[172:175], v[28:31], v[88:91], v[172:175]
ds_read_b64_tr_b16 v[66:67], v4 offset:12800
v_mfma_f32_16x16x32_bf16 v[156:159], v[28:31], v[84:87], v[156:159]
ds_read_b64_tr_b16 v[68:69], v5 offset:12288
v_mfma_f32_16x16x32_bf16 v[140:143], v[28:31], v[80:83], v[140:143]
ds_read_b64_tr_b16 v[70:71], v5 offset:12800
v_mfma_f32_16x16x32_bf16 v[192:195], v[32:35], v[80:83], v[192:195]
ds_read_b64_tr_b16 v[72:73], v6 offset:12288
v_mfma_f32_16x16x32_bf16 v[208:211], v[32:35], v[84:87], v[208:211]
ds_read_b64_tr_b16 v[74:75], v6 offset:12800
v_mfma_f32_16x16x32_bf16 v[224:227], v[32:35], v[88:91], v[224:227]
ds_read_b64_tr_b16 v[76:77], v7 offset:12288
v_mfma_f32_16x16x32_bf16 v[240:243], v[32:35], v[92:95], v[240:243]
ds_read_b64_tr_b16 v[78:79], v7 offset:12800
v_mfma_f32_16x16x32_bf16 v[244:247], v[36:39], v[92:95], v[244:247]
v_mfma_f32_16x16x32_bf16 v[228:231], v[36:39], v[88:91], v[228:231]
s_add_u32 s50, s50, 1
s_cmp_eq_u32 s50, 3
v_mfma_f32_16x16x32_bf16 v[212:215], v[36:39], v[84:87], v[212:215]
s_cselect_b32 s53, -2, 1
s_cselect_b32 s50, 0, s50
v_mfma_f32_16x16x32_bf16 v[196:199], v[36:39], v[80:83], v[196:199]
s_lshl_b32 s52, s53, 14
s_lshl_b32 s53, s53, 13
v_mfma_f32_16x16x32_bf16 v[200:203], v[40:43], v[80:83], v[200:203]
v_add_u32 v4, s52, v4
v_mfma_f32_16x16x32_bf16 v[216:219], v[40:43], v[84:87], v[216:219]
v_add_u32 v5, s52, v5
v_mfma_f32_16x16x32_bf16 v[232:235], v[40:43], v[88:91], v[232:235]
v_add_u32 v6, s52, v6
v_mfma_f32_16x16x32_bf16 v[248:251], v[40:43], v[92:95], v[248:251]
v_add_u32 v7, s52, v7
v_mfma_f32_16x16x32_bf16 v[252:255], v[44:47], v[92:95], v[252:255]
v_add_u32 v8, s53, v8
v_mfma_f32_16x16x32_bf16 v[236:239], v[44:47], v[88:91], v[236:239]
v_add_u32 v9, s53, v9
v_mfma_f32_16x16x32_bf16 v[220:223], v[44:47], v[84:87], v[220:223]
s_waitcnt lgkmcnt(0)
v_mfma_f32_16x16x32_bf16 v[204:207], v[44:47], v[80:83], v[204:207]
s_barrier
v_mfma_f32_16x16x32_bf16 v[128:131], v[48:51], v[96:99], v[128:131]
ds_read_b64_tr_b16 v[16:17], v4 offset:0
v_mfma_f32_16x16x32_bf16 v[144:147], v[48:51], v[100:103], v[144:147]
ds_read_b64_tr_b16 v[18:19], v4 offset:512
v_mfma_f32_16x16x32_bf16 v[160:163], v[48:51], v[104:107], v[160:163]
ds_read_b128 v[80:83], v8 offset:0
v_mfma_f32_16x16x32_bf16 v[176:179], v[48:51], v[108:111], v[176:179]
ds_read_b128 v[84:87], v8 offset:2048
v_mfma_f32_16x16x32_bf16 v[180:183], v[52:55], v[108:111], v[180:183]
ds_read_b128 v[88:91], v8 offset:4096
v_mfma_f32_16x16x32_bf16 v[164:167], v[52:55], v[104:107], v[164:167]
ds_read_b128 v[92:95], v8 offset:6144
v_mfma_f32_16x16x32_bf16 v[148:151], v[52:55], v[100:103], v[148:151]
ds_read_b64_tr_b16 v[20:21], v5 offset:0
v_mfma_f32_16x16x32_bf16 v[132:135], v[52:55], v[96:99], v[132:135]
ds_read_b64_tr_b16 v[22:23], v5 offset:512
v_mfma_f32_16x16x32_bf16 v[136:139], v[56:59], v[96:99], v[136:139]
ds_read_b64_tr_b16 v[24:25], v6 offset:0
v_mfma_f32_16x16x32_bf16 v[152:155], v[56:59], v[100:103], v[152:155]
ds_read_b64_tr_b16 v[26:27], v6 offset:512
v_mfma_f32_16x16x32_bf16 v[168:171], v[56:59], v[104:107], v[168:171]
ds_read_b64_tr_b16 v[28:29], v7 offset:0
v_mfma_f32_16x16x32_bf16 v[184:187], v[56:59], v[108:111], v[184:187]
ds_read_b64_tr_b16 v[30:31], v7 offset:512
v_mfma_f32_16x16x32_bf16 v[188:191], v[60:63], v[108:111], v[188:191]
ds_read_b64_tr_b16 v[32:33], v4 offset:8192
v_mfma_f32_16x16x32_bf16 v[172:175], v[60:63], v[104:107], v[172:175]
ds_read_b64_tr_b16 v[34:35], v4 offset:8704
v_mfma_f32_16x16x32_bf16 v[156:159], v[60:63], v[100:103], v[156:159]
ds_read_b64_tr_b16 v[36:37], v5 offset:8192
v_mfma_f32_16x16x32_bf16 v[140:143], v[60:63], v[96:99], v[140:143]
ds_read_b64_tr_b16 v[38:39], v5 offset:8704
v_mfma_f32_16x16x32_bf16 v[192:195], v[64:67], v[96:99], v[192:195]
ds_read_b64_tr_b16 v[40:41], v6 offset:8192
v_mfma_f32_16x16x32_bf16 v[208:211], v[64:67], v[100:103], v[208:211]
ds_read_b64_tr_b16 v[42:43], v6 offset:8704
v_mfma_f32_16x16x32_bf16 v[224:227], v[64:67], v[104:107], v[224:227]
ds_read_b64_tr_b16 v[44:45], v7 offset:8192
v_mfma_f32_16x16x32_bf16 v[240:243], v[64:67], v[108:111], v[240:243]
ds_read_b64_tr_b16 v[46:47], v7 offset:8704
v_mfma_f32_16x16x32_bf16 v[244:247], v[68:71], v[108:111], v[244:247]
v_mfma_f32_16x16x32_bf16 v[228:231], v[68:71], v[104:107], v[228:231]
v_mfma_f32_16x16x32_bf16 v[212:215], v[68:71], v[100:103], v[212:215]
v_mfma_f32_16x16x32_bf16 v[196:199], v[68:71], v[96:99], v[196:199]
v_mfma_f32_16x16x32_bf16 v[200:203], v[72:75], v[96:99], v[200:203]
s_cmp_eq_u32 s51, s33
s_cbranch_scc1 L_arrive
L_arrived:
v_mfma_f32_16x16x32_bf16 v[216:219], v[72:75], v[100:103], v[216:219]
v_mfma_f32_16x16x32_bf16 v[232:235], v[72:75], v[104:107], v[232:235]
v_mfma_f32_16x16x32_bf16 v[248:251], v[72:75], v[108:111], v[248:251]
v_mfma_f32_16x16x32_bf16 v[252:255], v[76:79], v[108:111], v[252:255]
s_sub_u32 s51, s51, 1
s_cmp_lg_u32 s51, 0
v_mfma_f32_16x16x32_bf16 v[236:239], v[76:79], v[104:107], v[236:239]
v_mfma_f32_16x16x32_bf16 v[220:223], v[76:79], v[100:103], v[220:223]
s_waitcnt lgkmcnt(0)
v_mfma_f32_16x16x32_bf16 v[204:207], v[76:79], v[96:99], v[204:207]
s_cbranch_scc1 L_cloop
v_mfma_f32_16x16x32_bf16 v[128:131], v[16:19], v[80:83], v[128:131]
ds_read_b64_tr_b16 v[48:49], v4 offset:4096
buffer_load_dword v2, v3, s[8:11], 0 offen sc1
v_mfma_f32_16x16x32_bf16 v[144:147], v[16:19], v[84:87], v[144:147]
ds_read_b64_tr_b16 v[50:51], v4 offset:4608
v_mfma_f32_16x16x32_bf16 v[160:163], v[16:19], v[88:91], v[160:163]
ds_read_b128 v[96:99], v9 offset:0
v_mfma_f32_16x16x32_bf16 v[176:179], v[16:19], v[92:95], v[176:179]
ds_read_b128 v[100:103], v9 offset:2048
v_mfma_f32_16x16x32_bf16 v[180:183], v[20:23], v[92:95], v[180:183]
ds_read_b128 v[104:107], v9 offset:4096
v_mfma_f32_16x16x32_bf16 v[164:167], v[20:23], v[88:91], v[164:167]
ds_read_b128 v[108:111], v9 offset:6144
v_mfma_f32_16x16x32_bf16 v[148:151], v[20:23], v[84:87], v[148:151]
ds_read_b64_tr_b16 v[52:53], v5 offset:4096
v_mfma_f32_16x16x32_bf16 v[132:135], v[20:23], v[80:83], v[132:135]
ds_read_b64_tr_b16 v[54:55], v5 offset:4608
v_mfma_f32_16x16x32_bf16 v[136:139], v[24:27], v[80:83], v[136:139]
ds_read_b64_tr_b16 v[56:57], v6 offset:4096
v_mfma_f32_16x16x32_bf16 v[152:155], v[24:27], v[84:87], v[152:155]
ds_read_b64_tr_b16 v[58:59], v6 offset:4608
v_mfma_f32_16x16x32_bf16 v[168:171], v[24:27], v[88:91], v[168:171]
ds_read_b64_tr_b16 v[60:61], v7 offset:4096
v_mfma_f32_16x16x32_bf16 v[184:187], v[24:27], v[92:95], v[184:187]
ds_read_b64_tr_b16 v[62:63], v7 offset:4608
v_mfma_f32_16x16x32_bf16 v[188:191], v[28:31], v[92:95], v[188:191]
ds_read_b64_tr_b16 v[64:65], v4 offset:12288
v_mfma_f32_16x16x32_bf16 v[172:175], v[28:31], v[88:91], v[172:175]
ds_read_b64_tr_b16 v[66:67], v4 offset:12800
v_mfma_f32_16x16x32_bf16 v[156:159], v[28:31], v[84:87], v[156:159]
ds_read_b64_tr_b16 v[68:69], v5 offset:12288
v_mfma_f32_16x16x32_bf16 v[140:143], v[28:31], v[80:83], v[140:143]
ds_read_b64_tr_b16 v[70:71], v5 offset:12800
v_mfma_f32_16x16x32_bf16 v[192:195], v[32:35], v[80:83], v[192:195]
ds_read_b64_tr_b16 v[72:73], v6 offset:12288
v_mfma_f32_16x16x32_bf16 v[208:211], v[32:35], v[84:87], v[208:211]
ds_read_b64_tr_b16 v[74:75], v6 offset:12800
v_mfma_f32_16x16x32_bf16 v[224:227], v[32:35], v[88:91], v[224:227]
ds_read_b64_tr_b16 v[76:77], v7 offset:12288
v_mfma_f32_16x16x32_bf16 v[240:243], v[32:35], v[92:95], v[240:243]
ds_read_b64_tr_b16 v[78:79], v7 offset:12800
v_mfma_f32_16x16x32_bf16 v[244:247], v[36:39], v[92:95], v[244:247]
v_mfma_f32_16x16x32_bf16 v[228:231], v[36:39], v[88:91], v[228:231]
v_mfma_f32_16x16x32_bf16 v[212:215], v[36:39], v[84:87], v[212:215]
v_mfma_f32_16x16x32_bf16 v[196:199], v[36:39], v[80:83], v[196:199]
v_mfma_f32_16x16x32_bf16 v[200:203], v[40:43], v[80:83], v[200:203]
v_mfma_f32_16x16x32_bf16 v[216:219], v[40:43], v[84:87], v[216:219]
v_mfma_f32_16x16x32_bf16 v[232:235], v[40:43], v[88:91], v[232:235]
v_mfma_f32_16x16x32_bf16 v[248:251], v[40:43], v[92:95], v[248:251]
v_mfma_f32_16x16x32_bf16 v[252:255], v[44:47], v[92:95], v[252:255]
v_mfma_f32_16x16x32_bf16 v[236:239], v[44:47], v[88:91], v[236:239]
v_mfma_f32_16x16x32_bf16 v[220:223], v[44:47], v[84:87], v[220:223]
s_waitcnt lgkmcnt(0)
v_mfma_f32_16x16x32_bf16 v[204:207], v[44:47], v[80:83], v[204:207]
s_barrier
v_mfma_f32_16x16x32_bf16 v[128:131], v[48:51], v[96:99], v[128:131]
s_mov_b32 s52, 0xc0135761
s_mov_b32 s54, 0xbdd2d3e8
s_mov_b32 s55, 0xbdd2d3e8
v_mfma_f32_16x16x32_bf16 v[132:135], v[52:55], v[96:99], v[132:135]
v_mov_b32 v14, s52
v_mfma_f32_16x16x32_bf16 v[136:139], v[56:59], v[96:99], v[136:139]
v_mov_b32 v15, s52
v_mfma_f32_16x16x32_bf16 v[140:143], v[60:63], v[96:99], v[140:143]
v_mov_b32 v112, 1
v_mfma_f32_16x16x32_bf16 v[192:195], v[64:67], v[96:99], v[192:195]
v_mov_b32 v113, 2
v_mfma_f32_16x16x32_bf16 v[196:199], v[68:71], v[96:99], v[196:199]
v_mov_b32 v114, 4
v_mfma_f32_16x16x32_bf16 v[200:203], v[72:75], v[96:99], v[200:203]
v_mfma_f32_16x16x32_bf16 v[204:207], v[76:79], v[96:99], v[204:207]
v_mfma_f32_16x16x32_bf16 v[144:147], v[48:51], v[100:103], v[144:147]
v_mfma_f32_16x16x32_bf16 v[148:151], v[52:55], v[100:103], v[148:151]
v_mfma_f32_16x16x32_bf16 v[152:155], v[56:59], v[100:103], v[152:155]
v_mfma_f32_16x16x32_bf16 v[156:159], v[60:63], v[100:103], v[156:159]
v_mfma_f32_16x16x32_bf16 v[208:211], v[64:67], v[100:103], v[208:211]
v_mfma_f32_16x16x32_bf16 v[212:215], v[68:71], v[100:103], v[212:215]
v_mfma_f32_16x16x32_bf16 v[216:219], v[72:75], v[100:103], v[216:219]
v_mfma_f32_16x16x32_bf16 v[220:223], v[76:79], v[100:103], v[220:223]
v_mfma_f32_16x16x32_bf16 v[160:163], v[48:51], v[104:107], v[160:163]
v_mfma_f32_16x16x32_bf16 v[164:167], v[52:55], v[104:107], v[164:167]
v_mfma_f32_16x16x32_bf16 v[168:171], v[56:59], v[104:107], v[168:171]
v_mfma_f32_16x16x32_bf16 v[172:175], v[60:63], v[104:107], v[172:175]
v_mfma_f32_16x16x32_bf16 v[224:227], v[64:67], v[104:107], v[224:227]
v_mfma_f32_16x16x32_bf16 v[228:231], v[68:71], v[104:107], v[228:231]
v_mfma_f32_16x16x32_bf16 v[232:235], v[72:75], v[104:107], v[232:235]
v_mfma_f32_16x16x32_bf16 v[236:239], v[76:79], v[104:107], v[236:239]
v_mfma_f32_16x16x32_bf16 v[176:179], v[48:51], v[108:111], v[176:179]
v_mfma_f32_16x16x32_bf16 v[180:183], v[52:55], v[108:111], v[180:183]
v_mfma_f32_16x16x32_bf16 v[184:187], v[56:59], v[108:111], v[184:187]
v_mfma_f32_16x16x32_bf16 v[188:191], v[60:63], v[108:111], v[188:191]
v_mfma_f32_16x16x32_bf16 v[240:243], v[64:67], v[108:111], v[240:243]
v_mfma_f32_16x16x32_bf16 v[244:247], v[68:71], v[108:111], v[244:247]
v_mfma_f32_16x16x32_bf16 v[248:251], v[72:75], v[108:111], v[248:251]
v_mfma_f32_16x16x32_bf16 v[252:255], v[76:79], v[108:111], v[252:255]
L_dchk:
s_waitcnt vmcnt(0)
v_readlane_b32 s52, v2, 0
v_readlane_b32 s53, v2, 1
s_cmp_lt_u32 s53, 128
s_cbranch_scc1 L_dretry
s_cmp_lg_u32 s52, s58
s_cbranch_scc1 L_dslow
v_pk_mul_f32 v[16:17], v[128:129], v[128:129]
v_pk_mul_f32 v[18:19], v[130:131], v[130:131]
v_pk_mul_f32 v[20:21], v[132:133], v[132:133]
v_pk_mul_f32 v[22:23], v[134:135], v[134:135]
v_pk_fma_f32 v[16:17], v[16:17], s[54:55], v[14:15]
v_pk_fma_f32 v[18:19], v[18:19], s[54:55], v[14:15]
v_pk_fma_f32 v[20:21], v[20:21], s[54:55], v[14:15]
v_pk_fma_f32 v[22:23], v[22:23], s[54:55], v[14:15]
v_pk_mul_f32 v[16:17], v[16:17], v[128:129]
v_pk_mul_f32 v[18:19], v[18:19], v[130:131]
v_pk_mul_f32 v[20:21], v[20:21], v[132:133]
v_pk_mul_f32 v[22:23], v[22:23], v[134:135]
v_exp_f32 v16, v16
v_exp_f32 v17, v17
v_pk_mul_f32 v[24:25], v[128:129], v[192:193]
v_exp_f32 v18, v18
v_exp_f32 v19, v19
v_pk_mul_f32 v[26:27], v[130:131], v[194:195]
v_exp_f32 v20, v20
v_exp_f32 v21, v21
v_pk_mul_f32 v[28:29], v[132:133], v[196:197]
v_exp_f32 v22, v22
v_exp_f32 v23, v23
v_pk_mul_f32 v[30:31], v[134:135], v[198:199]
v_pk_add_f32 v[16:17], v[16:17], 1.0 op_sel_hi:[1,0]
v_pk_add_f32 v[18:19], v[18:19], 1.0 op_sel_hi:[1,0]
v_pk_add_f32 v[20:21], v[20:21], 1.0 op_sel_hi:[1,0]
v_pk_add_f32 v[22:23], v[22:23], 1.0 op_sel_hi:[1,0]
v_rcp_f32 v16, v16
v_rcp_f32 v17, v17
v_rcp_f32 v18, v18
v_rcp_f32 v19, v19
v_rcp_f32 v20, v20
v_rcp_f32 v21, v21
v_rcp_f32 v22, v22
v_rcp_f32 v23, v23
v_pk_mul_f32 v[24:25], v[24:25], v[16:17]
v_pk_mul_f32 v[26:27], v[26:27], v[18:19]
v_pk_mul_f32 v[28:29], v[28:29], v[20:21]
v_pk_mul_f32 v[30:31], v[30:31], v[22:23]
v_cvt_pk_bf16_f32 v64, v24, v25
v_cvt_pk_bf16_f32 v65, v26, v27
v_cvt_pk_bf16_f32 v66, v28, v29
v_cvt_pk_bf16_f32 v67, v30, v31
buffer_store_dwordx4 v[64:67], v12, s[16:19], s34 offen offset:0
v_pk_mul_f32 v[32:33], v[136:137], v[136:137]
v_pk_mul_f32 v[34:35], v[138:139], v[138:139]
v_pk_mul_f32 v[36:37], v[140:141], v[140:141]
v_pk_mul_f32 v[38:39], v[142:143], v[142:143]
v_pk_fma_f32 v[32:33], v[32:33], s[54:55], v[14:15]
v_pk_fma_f32 v[34:35], v[34:35], s[54:55], v[14:15]
v_pk_fma_f32 v[36:37], v[36:37], s[54:55], v[14:15]
v_pk_fma_f32 v[38:39], v[38:39], s[54:55], v[14:15]
v_pk_mul_f32 v[32:33], v[32:33], v[136:137]
v_pk_mul_f32 v[34:35], v[34:35], v[138:139]
v_pk_mul_f32 v[36:37], v[36:37], v[140:141]
v_pk_mul_f32 v[38:39], v[38:39], v[142:143]
v_exp_f32 v32, v32
v_exp_f32 v33, v33
v_pk_mul_f32 v[40:41], v[136:137], v[200:201]
v_exp_f32 v34, v34
v_exp_f32 v35, v35
v_pk_mul_f32 v[42:43], v[138:139], v[202:203]
v_exp_f32 v36, v36
v_exp_f32 v37, v37
v_pk_mul_f32 v[44:45], v[140:141], v[204:205]
v_exp_f32 v38, v38
v_exp_f32 v39, v39
v_pk_mul_f32 v[46:47], v[142:143], v[206:207]
v_pk_add_f32 v[32:33], v[32:33], 1.0 op_sel_hi:[1,0]
v_pk_add_f32 v[34:35], v[34:35], 1.0 op_sel_hi:[1,0]
v_pk_add_f32 v[36:37], v[36:37], 1.0 op_sel_hi:[1,0]
v_pk_add_f32 v[38:39], v[38:39], 1.0 op_sel_hi:[1,0]
v_rcp_f32 v32, v32
v_rcp_f32 v33, v33
v_rcp_f32 v34, v34
v_rcp_f32 v35, v35
v_rcp_f32 v36, v36
v_rcp_f32 v37, v37
v_rcp_f32 v38, v38
v_rcp_f32 v39, v39
v_pk_mul_f32 v[40:41], v[40:41], v[32:33]
v_pk_mul_f32 v[42:43], v[42:43], v[34:35]
v_pk_mul_f32 v[44:45], v[44:45], v[36:37]
v_pk_mul_f32 v[46:47], v[46:47], v[38:39]
v_cvt_pk_bf16_f32 v68, v40, v41
v_cvt_pk_bf16_f32 v69, v42, v43
v_cvt_pk_bf16_f32 v70, v44, v45
v_cvt_pk_bf16_f32 v71, v46, v47
buffer_store_dwordx4 v[68:71], v12, s[16:19], s34 offen offset:1024
s_add_u32 s34, s34, 114688
v_pk_mul_f32 v[16:17], v[144:145], v[144:145]
v_pk_mul_f32 v[18:19], v[146:147], v[146:147]
v_pk_mul_f32 v[20:21], v[148:149], v[148:149]
v_pk_mul_f32 v[22:23], v[150:151], v[150:151]
v_pk_fma_f32 v[16:17], v[16:17], s[54:55], v[14:15]
v_pk_fma_f32 v[18:19], v[18:19], s[54:55], v[14:15]
v_pk_fma_f32 v[20:21], v[20:21], s[54:55], v[14:15]
v_pk_fma_f32 v[22:23], v[22:23], s[54:55], v[14:15]
v_pk_mul_f32 v[16:17], v[16:17], v[144:145]
v_pk_mul_f32 v[18:19], v[18:19], v[146:147]
v_pk_mul_f32 v[20:21], v[20:21], v[148:149]
v_pk_mul_f32 v[22:23], v[22:23], v[150:151]
v_exp_f32 v16, v16
v_exp_f32 v17, v17
v_pk_mul_f32 v[24:25], v[144:145], v[208:209]
v_exp_f32 v18, v18
v_exp_f32 v19, v19
v_pk_mul_f32 v[26:27], v[146:147], v[210:211]
v_exp_f32 v20, v20
v_exp_f32 v21, v21
v_pk_mul_f32 v[28:29], v[148:149], v[212:213]
v_exp_f32 v22, v22
v_exp_f32 v23, v23
v_pk_mul_f32 v[30:31], v[150:151], v[214:215]
v_pk_add_f32 v[16:17], v[16:17], 1.0 op_sel_hi:[1,0]
v_pk_add_f32 v[18:19], v[18:19], 1.0 op_sel_hi:[1,0]
v_pk_add_f32 v[20:21], v[20:21], 1.0 op_sel_hi:[1,0]
v_pk_add_f32 v[22:23], v[22:23], 1.0 op_sel_hi:[1,0]
v_rcp_f32 v16, v16
v_rcp_f32 v17, v17
v_rcp_f32 v18, v18
v_rcp_f32 v19, v19
v_rcp_f32 v20, v20
v_rcp_f32 v21, v21
v_rcp_f32 v22, v22
v_rcp_f32 v23, v23
v_pk_mul_f32 v[24:25], v[24:25], v[16:17]
v_pk_mul_f32 v[26:27], v[26:27], v[18:19]
v_pk_mul_f32 v[28:29], v[28:29], v[20:21]
v_pk_mul_f32 v[30:31], v[30:31], v[22:23]
v_cvt_pk_bf16_f32 v72, v24, v25
v_cvt_pk_bf16_f32 v73, v26, v27
v_cvt_pk_bf16_f32 v74, v28, v29
v_cvt_pk_bf16_f32 v75, v30, v31
buffer_store_dwordx4 v[72:75], v12, s[16:19], s34 offen offset:0
v_pk_mul_f32 v[32:33], v[152:153], v[152:153]
v_pk_mul_f32 v[34:35], v[154:155], v[154:155]
v_pk_mul_f32 v[36:37], v[156:157], v[156:157]
v_pk_mul_f32 v[38:39], v[158:159], v[158:159]
v_pk_fma_f32 v[32:33], v[32:33], s[54:55], v[14:15]
v_pk_fma_f32 v[34:35], v[34:35], s[54:55], v[14:15]
v_pk_fma_f32 v[36:37], v[36:37], s[54:55], v[14:15]
v_pk_fma_f32 v[38:39], v[38:39], s[54:55], v[14:15]
v_pk_mul_f32 v[32:33], v[32:33], v[152:153]
v_pk_mul_f32 v[34:35], v[34:35], v[154:155]
v_pk_mul_f32 v[36:37], v[36:37], v[156:157]
v_pk_mul_f32 v[38:39], v[38:39], v[158:159]
v_exp_f32 v32, v32
v_exp_f32 v33, v33
v_pk_mul_f32 v[40:41], v[152:153], v[216:217]
v_exp_f32 v34, v34
v_exp_f32 v35, v35
v_pk_mul_f32 v[42:43], v[154:155], v[218:219]
v_exp_f32 v36, v36
v_exp_f32 v37, v37
v_pk_mul_f32 v[44:45], v[156:157], v[220:221]
v_exp_f32 v38, v38
v_exp_f32 v39, v39
v_pk_mul_f32 v[46:47], v[158:159], v[222:223]
v_pk_add_f32 v[32:33], v[32:33], 1.0 op_sel_hi:[1,0]
v_pk_add_f32 v[34:35], v[34:35], 1.0 op_sel_hi:[1,0]
v_pk_add_f32 v[36:37], v[36:37], 1.0 op_sel_hi:[1,0]
v_pk_add_f32 v[38:39], v[38:39], 1.0 op_sel_hi:[1,0]
v_rcp_f32 v32, v32
v_rcp_f32 v33, v33
v_rcp_f32 v34, v34
v_rcp_f32 v35, v35
v_rcp_f32 v36, v36
v_rcp_f32 v37, v37
v_rcp_f32 v38, v38
v_rcp_f32 v39, v39
v_pk_mul_f32 v[40:41], v[40:41], v[32:33]
v_pk_mul_f32 v[42:43], v[42:43], v[34:35]
v_pk_mul_f32 v[44:45], v[44:45], v[36:37]
v_pk_mul_f32 v[46:47], v[46:47], v[38:39]
v_cvt_pk_bf16_f32 v76, v40, v41
v_cvt_pk_bf16_f32 v77, v42, v43
v_cvt_pk_bf16_f32 v78, v44, v45
v_cvt_pk_bf16_f32 v79, v46, v47
s_waitcnt vmcnt(1)
buffer_store_dword v112, v1, s[16:19], s96 offen
buffer_store_dwordx4 v[76:79], v12, s[16:19], s34 offen offset:1024
s_add_u32 s34, s34, 114688
v_pk_mul_f32 v[16:17], v[160:161], v[160:161]
v_pk_mul_f32 v[18:19], v[162:163], v[162:163]
v_pk_mul_f32 v[20:21], v[164:165], v[164:165]
v_pk_mul_f32 v[22:23], v[166:167], v[166:167]
v_pk_fma_f32 v[16:17], v[16:17], s[54:55], v[14:15]
v_pk_fma_f32 v[18:19], v[18:19], s[54:55], v[14:15]
v_pk_fma_f32 v[20:21], v[20:21], s[54:55], v[14:15]
v_pk_fma_f32 v[22:23], v[22:23], s[54:55], v[14:15]
v_pk_mul_f32 v[16:17], v[16:17], v[160:161]
v_pk_mul_f32 v[18:19], v[18:19], v[162:163]
v_pk_mul_f32 v[20:21], v[20:21], v[164:165]
v_pk_mul_f32 v[22:23], v[22:23], v[166:167]
v_exp_f32 v16, v16
v_exp_f32 v17, v17
v_pk_mul_f32 v[24:25], v[160:161], v[224:225]
v_exp_f32 v18, v18
v_exp_f32 v19, v19
v_pk_mul_f32 v[26:27], v[162:163], v[226:227]
v_exp_f32 v20, v20
v_exp_f32 v21, v21
v_pk_mul_f32 v[28:29], v[164:165], v[228:229]
v_exp_f32 v22, v22
v_exp_f32 v23, v23
v_pk_mul_f32 v[30:31], v[166:167], v[230:231]
v_pk_add_f32 v[16:17], v[16:17], 1.0 op_sel_hi:[1,0]
v_pk_add_f32 v[18:19], v[18:19], 1.0 op_sel_hi:[1,0]
v_pk_add_f32 v[20:21], v[20:21], 1.0 op_sel_hi:[1,0]
v_pk_add_f32 v[22:23], v[22:23], 1.0 op_sel_hi:[1,0]
v_rcp_f32 v16, v16
v_rcp_f32 v17, v17
v_rcp_f32 v18, v18
v_rcp_f32 v19, v19
v_rcp_f32 v20, v20
v_rcp_f32 v21, v21
v_rcp_f32 v22, v22
v_rcp_f32 v23, v23
v_pk_mul_f32 v[24:25], v[24:25], v[16:17]
v_pk_mul_f32 v[26:27], v[26:27], v[18:19]
v_pk_mul_f32 v[28:29], v[28:29], v[20:21]
v_pk_mul_f32 v[30:31], v[30:31], v[22:23]
v_cvt_pk_bf16_f32 v80, v24, v25
v_cvt_pk_bf16_f32 v81, v26, v27
v_cvt_pk_bf16_f32 v82, v28, v29
v_cvt_pk_bf16_f32 v83, v30, v31
buffer_store_dwordx4 v[80:83], v12, s[16:19], s34 offen offset:0
v_pk_mul_f32 v[32:33], v[168:169], v[168:169]
v_pk_mul_f32 v[34:35], v[170:171], v[170:171]
v_pk_mul_f32 v[36:37], v[172:173], v[172:173]
v_pk_mul_f32 v[38:39], v[174:175], v[174:175]
v_pk_fma_f32 v[32:33], v[32:33], s[54:55], v[14:15]
v_pk_fma_f32 v[34:35], v[34:35], s[54:55], v[14:15]
v_pk_fma_f32 v[36:37], v[36:37], s[54:55], v[14:15]
v_pk_fma_f32 v[38:39], v[38:39], s[54:55], v[14:15]
v_pk_mul_f32 v[32:33], v[32:33], v[168:169]
v_pk_mul_f32 v[34:35], v[34:35], v[170:171]
v_pk_mul_f32 v[36:37], v[36:37], v[172:173]
v_pk_mul_f32 v[38:39], v[38:39], v[174:175]
v_exp_f32 v32, v32
v_exp_f32 v33, v33
v_pk_mul_f32 v[40:41], v[168:169], v[232:233]
v_exp_f32 v34, v34
v_exp_f32 v35, v35
v_pk_mul_f32 v[42:43], v[170:171], v[234:235]
v_exp_f32 v36, v36
v_exp_f32 v37, v37
v_pk_mul_f32 v[44:45], v[172:173], v[236:237]
v_exp_f32 v38, v38
v_exp_f32 v39, v39
v_pk_mul_f32 v[46:47], v[174:175], v[238:239]
v_pk_add_f32 v[32:33], v[32:33], 1.0 op_sel_hi:[1,0]
v_pk_add_f32 v[34:35], v[34:35], 1.0 op_sel_hi:[1,0]
v_pk_add_f32 v[36:37], v[36:37], 1.0 op_sel_hi:[1,0]
v_pk_add_f32 v[38:39], v[38:39], 1.0 op_sel_hi:[1,0]
v_rcp_f32 v32, v32
v_rcp_f32 v33, v33
v_rcp_f32 v34, v34
v_rcp_f32 v35, v35
v_rcp_f32 v36, v36
v_rcp_f32 v37, v37
v_rcp_f32 v38, v38
v_rcp_f32 v39, v39
v_pk_mul_f32 v[40:41], v[40:41], v[32:33]
v_pk_mul_f32 v[42:43], v[42:43], v[34:35]
v_pk_mul_f32 v[44:45], v[44:45], v[36:37]
v_pk_mul_f32 v[46:47], v[46:47], v[38:39]
v_cvt_pk_bf16_f32 v84, v40, v41
v_cvt_pk_bf16_f32 v85, v42, v43
v_cvt_pk_bf16_f32 v86, v44, v45
v_cvt_pk_bf16_f32 v87, v46, v47
s_waitcnt vmcnt(1)
buffer_store_dword v113, v1, s[16:19], s96 offen
buffer_store_dwordx4 v[84:87], v12, s[16:19], s34 offen offset:1024
s_add_u32 s34, s34, 114688
buffer_load_dword v2, v116, s[16:19], s97 offen sc1
v_pk_mul_f32 v[16:17], v[176:177], v[176:177]
v_pk_mul_f32 v[18:19], v[178:179], v[178:179]
v_pk_mul_f32 v[20:21], v[180:181], v[180:181]
v_pk_mul_f32 v[22:23], v[182:183], v[182:183]
v_pk_fma_f32 v[16:17], v[16:17], s[54:55], v[14:15]
v_pk_fma_f32 v[18:19], v[18:19], s[54:55], v[14:15]
v_pk_fma_f32 v[20:21], v[20:21], s[54:55], v[14:15]
v_pk_fma_f32 v[22:23], v[22:23], s[54:55], v[14:15]
v_pk_mul_f32 v[16:17], v[16:17], v[176:177]
v_pk_mul_f32 v[18:19], v[18:19], v[178:179]
v_pk_mul_f32 v[20:21], v[20:21], v[180:181]
v_pk_mul_f32 v[22:23], v[22:23], v[182:183]
v_exp_f32 v16, v16
v_exp_f32 v17, v17
v_pk_mul_f32 v[24:25], v[176:177], v[240:241]
v_exp_f32 v18, v18
v_exp_f32 v19, v19
v_pk_mul_f32 v[26:27], v[178:179], v[242:243]
v_exp_f32 v20, v20
v_exp_f32 v21, v21
v_pk_mul_f32 v[28:29], v[180:181], v[244:245]
v_exp_f32 v22, v22
v_exp_f32 v23, v23
v_pk_mul_f32 v[30:31], v[182:183], v[246:247]
v_pk_add_f32 v[16:17], v[16:17], 1.0 op_sel_hi:[1,0]
v_pk_add_f32 v[18:19], v[18:19], 1.0 op_sel_hi:[1,0]
v_pk_add_f32 v[20:21], v[20:21], 1.0 op_sel_hi:[1,0]
v_pk_add_f32 v[22:23], v[22:23], 1.0 op_sel_hi:[1,0]
v_rcp_f32 v16, v16
v_rcp_f32 v17, v17
v_rcp_f32 v18, v18
v_rcp_f32 v19, v19
v_rcp_f32 v20, v20
v_rcp_f32 v21, v21
v_rcp_f32 v22, v22
v_rcp_f32 v23, v23
v_pk_mul_f32 v[24:25], v[24:25], v[16:17]
v_pk_mul_f32 v[26:27], v[26:27], v[18:19]
v_pk_mul_f32 v[28:29], v[28:29], v[20:21]
v_pk_mul_f32 v[30:31], v[30:31], v[22:23]
v_cvt_pk_bf16_f32 v88, v24, v25
v_cvt_pk_bf16_f32 v89, v26, v27
v_cvt_pk_bf16_f32 v90, v28, v29
v_cvt_pk_bf16_f32 v91, v30, v31
buffer_store_dwordx4 v[88:91], v12, s[16:19], s34 offen offset:0
v_pk_mul_f32 v[32:33], v[184:185], v[184:185]
v_pk_mul_f32 v[34:35], v[186:187], v[186:187]
v_pk_mul_f32 v[36:37], v[188:189], v[188:189]
v_pk_mul_f32 v[38:39], v[190:191], v[190:191]
v_pk_fma_f32 v[32:33], v[32:33], s[54:55], v[14:15]
v_pk_fma_f32 v[34:35], v[34:35], s[54:55], v[14:15]
v_pk_fma_f32 v[36:37], v[36:37], s[54:55], v[14:15]
v_pk_fma_f32 v[38:39], v[38:39], s[54:55], v[14:15]
v_pk_mul_f32 v[32:33], v[32:33], v[184:185]
v_pk_mul_f32 v[34:35], v[34:35], v[186:187]
v_pk_mul_f32 v[36:37], v[36:37], v[188:189]
v_pk_mul_f32 v[38:39], v[38:39], v[190:191]
v_exp_f32 v32, v32
v_exp_f32 v33, v33
v_pk_mul_f32 v[40:41], v[184:185], v[248:249]
v_exp_f32 v34, v34
v_exp_f32 v35, v35
v_pk_mul_f32 v[42:43], v[186:187], v[250:251]
v_exp_f32 v36, v36
v_exp_f32 v37, v37
v_pk_mul_f32 v[44:45], v[188:189], v[252:253]
v_exp_f32 v38, v38
v_exp_f32 v39, v39
v_pk_mul_f32 v[46:47], v[190:191], v[254:255]
v_pk_add_f32 v[32:33], v[32:33], 1.0 op_sel_hi:[1,0]
v_pk_add_f32 v[34:35], v[34:35], 1.0 op_sel_hi:[1,0]
v_pk_add_f32 v[36:37], v[36:37], 1.0 op_sel_hi:[1,0]
v_pk_add_f32 v[38:39], v[38:39], 1.0 op_sel_hi:[1,0]
v_rcp_f32 v32, v32
v_rcp_f32 v33, v33
v_rcp_f32 v34, v34
v_rcp_f32 v35, v35
v_rcp_f32 v36, v36
v_rcp_f32 v37, v37
v_rcp_f32 v38, v38
v_rcp_f32 v39, v39
v_pk_mul_f32 v[40:41], v[40:41], v[32:33]
v_pk_mul_f32 v[42:43], v[42:43], v[34:35]
v_pk_mul_f32 v[44:45], v[44:45], v[36:37]
v_pk_mul_f32 v[46:47], v[46:47], v[38:39]
v_cvt_pk_bf16_f32 v92, v40, v41
v_cvt_pk_bf16_f32 v93, v42, v43
v_cvt_pk_bf16_f32 v94, v44, v45
v_cvt_pk_bf16_f32 v95, v46, v47
buffer_store_dwordx4 v[92:95], v12, s[16:19], s34 offen offset:1024
s_add_u32 s34, s34, 114688
s_waitcnt vmcnt(2)
v_cmp_gt_u32 vcc, 1, v2
s_and_b32 s50, vcc_lo, 0x3fff3fff
s_cbranch_scc1 L_nef
s_add_u32 m0, s37, 0
s_add_u32 s52, s36, 0
buffer_load_dwordx4 v12, s[16:19], s52 offen offset:0 sc1 lds
buffer_load_dwordx4 v12, s[16:19], s52 offen offset:1024 sc1 lds
buffer_load_dwordx4 v12, s[16:19], s52 offen offset:2048 sc1 lds
buffer_load_dwordx4 v12, s[16:19], s52 offen offset:3072 sc1 lds
s_add_u32 m0, s37, 4096
s_add_u32 s52, s36, 4096
buffer_load_dwordx4 v12, s[16:19], s52 offen offset:0 sc1 lds
buffer_load_dwordx4 v12, s[16:19], s52 offen offset:1024 sc1 lds
buffer_load_dwordx4 v12, s[16:19], s52 offen offset:2048 sc1 lds
s_add_u32 m0, s38, 0
s_add_u32 s52, s36, 458752
buffer_load_dwordx4 v12, s[16:19], s52 offen offset:0 sc1 lds
buffer_load_dwordx4 v12, s[16:19], s52 offen offset:1024 sc1 lds
buffer_load_dwordx4 v12, s[16:19], s52 offen offset:2048 sc1 lds
buffer_load_dwordx4 v12, s[16:19], s52 offen offset:3072 sc1 lds
s_add_u32 m0, s38, 4096
s_add_u32 s52, s36, 462848
buffer_load_dwordx4 v12, s[16:19], s52 offen offset:0 sc1 lds
buffer_load_dwordx4 v12, s[16:19], s52 offen offset:1024 sc1 lds
buffer_load_dwordx4 v12, s[16:19], s52 offen offset:2048 sc1 lds
s_waitcnt vmcnt(14)
buffer_store_dword v114, v1, s[16:19], s96 offen
s_waitcnt vmcnt(8)
L_g2h:
s_barrier
L_fca:
v_cmp_gt_u32 vcc, 2, v2
s_and_b32 vcc_lo, vcc_lo, 1073692671
s_cbranch_scc1 L_fra
L_foa:
s_add_u32 m0, s37, 8192
s_add_u32 s52, s36, 114688
buffer_load_dwordx4 v12, s[16:19], s52 offen offset:0 sc1 lds
buffer_load_dwordx4 v12, s[16:19], s52 offen offset:1024 sc1 lds
buffer_load_dwordx4 v12, s[16:19], s52 offen offset:2048 sc1 lds
buffer_load_dwordx4 v12, s[16:19], s52 offen offset:3072 sc1 lds
s_add_u32 m0, s37, 12288
s_add_u32 s52, s36, 118784
buffer_load_dwordx4 v12, s[16:19], s52 offen offset:0 sc1 lds
buffer_load_dwordx4 v12, s[16:19], s52 offen offset:1024 sc1 lds
buffer_load_dwordx4 v12, s[16:19], s52 offen offset:2048 sc1 lds
s_add_u32 m0, s37, 16384
s_add_u32 s52, s36, 573440
buffer_load_dwordx4 v12, s[16:19], s52 offen offset:0 sc1 lds
buffer_load_dwordx4 v12, s[16:19], s52 offen offset:1024 sc1 lds
buffer_load_dwordx4 v12, s[16:19], s52 offen offset:2048 sc1 lds
buffer_load_dwordx4 v12, s[16:19], s52 offen offset:3072 sc1 lds
s_add_u32 m0, s37, 20480
s_add_u32 s52, s36, 577536
buffer_load_dwordx4 v12, s[16:19], s52 offen offset:0 sc1 lds
buffer_load_dwordx4 v12, s[16:19], s52 offen offset:1024 sc1 lds
buffer_load_dwordx4 v12, s[16:19], s52 offen offset:2048 sc1 lds
buffer_load_dword v2, v116, s[16:19], s97 offen sc1
s_waitcnt vmcnt(15)
s_barrier
s_waitcnt vmcnt(8)
s_barrier
s_waitcnt vmcnt(0)
L_fcb:
v_cmp_gt_u32 vcc, 4, v2
s_and_b32 vcc_lo, vcc_lo, 1073692671
s_cbranch_scc1 L_frb
L_fob:
s_add_u32 m0, s37, 0
s_add_u32 s52, s36, 229376
buffer_load_dwordx4 v12, s[16:19], s52 offen offset:0 sc1 lds
buffer_load_dwordx4 v12, s[16:19], s52 offen offset:1024 sc1 lds
buffer_load_dwordx4 v12, s[16:19], s52 offen offset:2048 sc1 lds
buffer_load_dwordx4 v12, s[16:19], s52 offen offset:3072 sc1 lds
s_add_u32 m0, s37, 4096
s_add_u32 s52, s36, 233472
buffer_load_dwordx4 v12, s[16:19], s52 offen offset:0 sc1 lds
buffer_load_dwordx4 v12, s[16:19], s52 offen offset:1024 sc1 lds
buffer_load_dwordx4 v12, s[16:19], s52 offen offset:2048 sc1 lds
s_barrier
s_add_u32 m0, s38, 0
s_add_u32 s52, s36, 688128
buffer_load_dwordx4 v12, s[16:19], s52 offen offset:0 sc1 lds
buffer_load_dwordx4 v12, s[16:19], s52 offen offset:1024 sc1 lds
buffer_load_dwordx4 v12, s[16:19], s52 offen offset:2048 sc1 lds
buffer_load_dwordx4 v12, s[16:19], s52 offen offset:3072 sc1 lds
s_add_u32 m0, s38, 4096
s_add_u32 s52, s36, 692224
buffer_load_dwordx4 v12, s[16:19], s52 offen offset:0 sc1 lds
buffer_load_dwordx4 v12, s[16:19], s52 offen offset:1024 sc1 lds
buffer_load_dwordx4 v12, s[16:19], s52 offen offset:2048 sc1 lds
s_waitcnt vmcnt(7)
s_barrier
s_add_u32 m0, s37, 8192
s_add_u32 s52, s36, 344064
buffer_load_dwordx4 v12, s[16:19], s52 offen offset:0 sc1 lds
buffer_load_dwordx4 v12, s[16:19], s52 offen offset:1024 sc1 lds
buffer_load_dwordx4 v12, s[16:19], s52 offen offset:2048 sc1 lds
buffer_load_dwordx4 v12, s[16:19], s52 offen offset:3072 sc1 lds
s_add_u32 m0, s37, 12288
s_add_u32 s52, s36, 348160
buffer_load_dwordx4 v12, s[16:19], s52 offen offset:0 sc1 lds
buffer_load_dwordx4 v12, s[16:19], s52 offen offset:1024 sc1 lds
buffer_load_dwordx4 v12, s[16:19], s52 offen offset:2048 sc1 lds
s_waitcnt vmcnt(7)
s_barrier
s_add_u32 m0, s37, 16384
s_add_u32 s52, s36, 802816
buffer_load_dwordx4 v12, s[16:19], s52 offen offset:0 sc1 lds
buffer_load_dwordx4 v12, s[16:19], s52 offen offset:1024 sc1 lds
buffer_load_dwordx4 v12, s[16:19], s52 offen offset:2048 sc1 lds
buffer_load_dwordx4 v12, s[16:19], s52 offen offset:3072 sc1 lds
s_add_u32 m0, s37, 20480
s_add_u32 s52, s36, 806912
buffer_load_dwordx4 v12, s[16:19], s52 offen offset:0 sc1 lds
buffer_load_dwordx4 v12, s[16:19], s52 offen offset:1024 sc1 lds
buffer_load_dwordx4 v12, s[16:19], s52 offen offset:2048 sc1 lds
s_waitcnt vmcnt(7)
s_barrier
buffer_load_dword v2, v116, s[16:19], s22 offen sc1
s_waitcnt vmcnt(1)
s_barrier
L_tail:
s_waitcnt vmcnt(0)
L_fcd:
v_cmp_gt_u32 vcc, 1, v2
s_and_b32 vcc_lo, vcc_lo, 1
s_cbranch_scc1 L_frd
L_fod:
s_add_u32 s52, s23, 0
buffer_load_dwordx4 v[16:19], v12, s[16:19], s52 offen sc1
s_add_u32 s52, s23, 8192
buffer_load_dwordx4 v[24:27], v12, s[16:19], s52 offen sc1
s_add_u32 s52, s23, 16384
buffer_load_dwordx4 v[32:35], v12, s[16:19], s52 offen sc1
s_add_u32 s52, s23, 4096
buffer_load_dwordx4 v[20:23], v12, s[16:19], s52 offen sc1
s_add_u32 s52, s23, 12288
buffer_load_dwordx4 v[28:31], v12, s[16:19], s52 offen sc1
s_barrier
s_add_u32 s52, s23, 20480
buffer_load_dwordx4 v[36:39], v12, s[16:19], s52 offen sc1
ds_read_b128 v[48:51], v11 offset:0
ds_read_b128 v[52:55], v11 offset:1024
s_waitcnt vmcnt(1)
L_chkr0:
v_max_u32 v96, v24, v25
v_max3_u32 v96, v26, v27, v96
v_max3_u32 v96, v28, v29, v96
v_max3_u32 v96, v30, v31, v96
v_max3_u32 v96, v32, v33, v96
v_max3_u32 v96, v34, v35, v96
v_cmp_eq_u32 vcc, -1, v96
s_cbranch_vccnz L_rtyr0
L_okr0:
s_waitcnt lgkmcnt(0)
v_lshlrev_b32 v80, 16, v16
v_and_b32 v81, 0xffff0000, v16
v_lshlrev_b32 v82, 16, v17
v_and_b32 v83, 0xffff0000, v17
v_lshlrev_b32 v84, 16, v18
v_and_b32 v85, 0xffff0000, v18
v_lshlrev_b32 v86, 16, v19
v_and_b32 v87, 0xffff0000, v19
v_pk_add_f32 v[48:49], v[48:49], v[80:81]
v_pk_add_f32 v[50:51], v[50:51], v[82:83]
v_pk_add_f32 v[52:53], v[52:53], v[84:85]
v_pk_add_f32 v[54:55], v[54:55], v[86:87]
v_lshlrev_b32 v80, 16, v24
v_and_b32 v81, 0xffff0000, v24
v_lshlrev_b32 v82, 16, v25
v_and_b32 v83, 0xffff0000, v25
v_lshlrev_b32 v84, 16, v26
v_and_b32 v85, 0xffff0000, v26
v_lshlrev_b32 v86, 16, v27
v_and_b32 v87, 0xffff0000, v27
v_pk_add_f32 v[48:49], v[48:49], v[80:81]
v_pk_add_f32 v[50:51], v[50:51], v[82:83]
v_pk_add_f32 v[52:53], v[52:53], v[84:85]
v_pk_add_f32 v[54:55], v[54:55], v[86:87]
v_lshlrev_b32 v80, 16, v32
v_and_b32 v81, 0xffff0000, v32
v_lshlrev_b32 v82, 16, v33
v_and_b32 v83, 0xffff0000, v33
v_lshlrev_b32 v84, 16, v34
v_and_b32 v85, 0xffff0000, v34
v_lshlrev_b32 v86, 16, v35
v_and_b32 v87, 0xffff0000, v35
v_pk_add_f32 v[48:49], v[48:49], v[80:81]
v_pk_add_f32 v[50:51], v[50:51], v[82:83]
v_pk_add_f32 v[52:53], v[52:53], v[84:85]
v_pk_add_f32 v[54:55], v[54:55], v[86:87]
v_cvt_pk_bf16_f32 v48, v48, v49
v_cvt_pk_bf16_f32 v49, v50, v51
v_cvt_pk_bf16_f32 v50, v52, v53
v_cvt_pk_bf16_f32 v51, v54, v55
s_nop 1
v_permlane16_swap_b32 v48, v50
v_permlane16_swap_b32 v49, v51
buffer_store_dwordx4 v[48:51], v13, s[4:7], s57 offen nt
s_add_u32 s57, s57, 131072
v_lshlrev_b32 v64, 16, v20
v_and_b32 v65, 0xffff0000, v20
v_lshlrev_b32 v66, 16, v21
v_and_b32 v67, 0xffff0000, v21
v_lshlrev_b32 v68, 16, v22
v_and_b32 v69, 0xffff0000, v22
v_lshlrev_b32 v70, 16, v23
v_and_b32 v71, 0xffff0000, v23
v_lshlrev_b32 v80, 16, v28
v_and_b32 v81, 0xffff0000, v28
v_lshlrev_b32 v82, 16, v29
v_and_b32 v83, 0xffff0000, v29
v_lshlrev_b32 v84, 16, v30
v_and_b32 v85, 0xffff0000, v30
v_lshlrev_b32 v86, 16, v31
v_and_b32 v87, 0xffff0000, v31
v_pk_add_f32 v[64:65], v[64:65], v[80:81]
v_pk_add_f32 v[66:67], v[66:67], v[82:83]
v_pk_add_f32 v[68:69], v[68:69], v[84:85]
v_pk_add_f32 v[70:71], v[70:71], v[86:87]
s_waitcnt vmcnt(1)
L_chkr1:
v_max_u32 v96, v36, v37
v_max3_u32 v96, v38, v39, v96
v_cmp_eq_u32 vcc, -1, v96
s_cbranch_vccnz L_rtyr1
L_okr1:
v_lshlrev_b32 v80, 16, v36
v_and_b32 v81, 0xffff0000, v36
v_lshlrev_b32 v82, 16, v37
v_and_b32 v83, 0xffff0000, v37
v_lshlrev_b32 v84, 16, v38
v_and_b32 v85, 0xffff0000, v38
v_lshlrev_b32 v86, 16, v39
v_and_b32 v87, 0xffff0000, v39
v_pk_add_f32 v[64:65], v[64:65], v[80:81]
v_pk_add_f32 v[66:67], v[66:67], v[82:83]
v_pk_add_f32 v[68:69], v[68:69], v[84:85]
v_pk_add_f32 v[70:71], v[70:71], v[86:87]
s_barrier
ds_read_b128 v[80:83], v11 offset:8192
ds_read_b128 v[84:87], v11 offset:9216
s_waitcnt lgkmcnt(0)
v_pk_add_f32 v[64:65], v[64:65], v[80:81]
v_pk_add_f32 v[66:67], v[66:67], v[82:83]
v_pk_add_f32 v[68:69], v[68:69], v[84:85]
v_pk_add_f32 v[70:71], v[70:71], v[86:87]
v_cvt_pk_bf16_f32 v64, v64, v65
v_cvt_pk_bf16_f32 v65, v66, v67
v_cvt_pk_bf16_f32 v66, v68, v69
v_cvt_pk_bf16_f32 v67, v70, v71
s_nop 1
v_permlane16_swap_b32 v64, v66
v_permlane16_swap_b32 v65, v67
buffer_store_dwordx4 v[64:67], v13, s[4:7], s57 offen nt
s_endpgm
L_nef:
buffer_load_dword v2, v116, s[16:19], s97 offen sc1
s_waitcnt vmcnt(1)
buffer_store_dword v114, v1, s[16:19], s96 offen
s_branch L_late
L_late:
s_waitcnt vmcnt(1)
L_fcc:
v_cmp_gt_u32 vcc, 1, v2
s_and_b32 vcc_lo, vcc_lo, 1073692671
s_cbranch_scc1 L_frc
L_foc:
s_add_u32 m0, s37, 0
s_add_u32 s52, s36, 0
buffer_load_dwordx4 v12, s[16:19], s52 offen offset:0 sc1 lds
buffer_load_dwordx4 v12, s[16:19], s52 offen offset:1024 sc1 lds
buffer_load_dwordx4 v12, s[16:19], s52 offen offset:2048 sc1 lds
buffer_load_dwordx4 v12, s[16:19], s52 offen offset:3072 sc1 lds
s_add_u32 m0, s37, 4096
s_add_u32 s52, s36, 4096
buffer_load_dwordx4 v12, s[16:19], s52 offen offset:0 sc1 lds
buffer_load_dwordx4 v12, s[16:19], s52 offen offset:1024 sc1 lds
buffer_load_dwordx4 v12, s[16:19], s52 offen offset:2048 sc1 lds
s_add_u32 m0, s38, 0
s_add_u32 s52, s36, 458752
buffer_load_dwordx4 v12, s[16:19], s52 offen offset:0 sc1 lds
buffer_load_dwordx4 v12, s[16:19], s52 offen offset:1024 sc1 lds
buffer_load_dwordx4 v12, s[16:19], s52 offen offset:2048 sc1 lds
buffer_load_dwordx4 v12, s[16:19], s52 offen offset:3072 sc1 lds
s_add_u32 m0, s38, 4096
s_add_u32 s52, s36, 462848
buffer_load_dwordx4 v12, s[16:19], s52 offen offset:0 sc1 lds
buffer_load_dwordx4 v12, s[16:19], s52 offen offset:1024 sc1 lds
buffer_load_dwordx4 v12, s[16:19], s52 offen offset:2048 sc1 lds
s_waitcnt vmcnt(7)
s_branch L_g2h
L_fra:
s_sub_u32 s59, s59, 1
s_cbranch_scc1 L_fga
s_sleep 1
buffer_load_dword v2, v116, s[16:19], s97 offen sc1
s_waitcnt vmcnt(0)
s_branch L_fca
L_fga:
s_mov_b32 s59, 0
s_branch L_foa
L_frb:
s_sub_u32 s59, s59, 1
s_cbranch_scc1 L_fgb
s_sleep 1
buffer_load_dword v2, v116, s[16:19], s97 offen sc1
s_waitcnt vmcnt(0)
s_branch L_fcb
L_fgb:
s_mov_b32 s59, 0
s_branch L_fob
L_frd:
s_sub_u32 s59, s59, 1
s_cbranch_scc1 L_fgd
s_sleep 1
buffer_load_dword v2, v116, s[16:19], s22 offen sc1
s_waitcnt vmcnt(0)
s_branch L_fcd
L_fgd:
s_mov_b32 s59, 0
s_branch L_fod
L_rtyr0:
s_sub_u32 s59, s59, 1
s_cbranch_scc1 L_giver0
s_add_u32 s52, s23, 8192
buffer_load_dwordx4 v[24:27], v12, s[16:19], s52 offen sc1
s_add_u32 s52, s23, 12288
buffer_load_dwordx4 v[28:31], v12, s[16:19], s52 offen sc1
s_add_u32 s52, s23, 16384
buffer_load_dwordx4 v[32:35], v12, s[16:19], s52 offen sc1
s_add_u32 s52, s23, 20480
buffer_load_dwordx4 v[36:39], v12, s[16:19], s52 offen sc1
s_waitcnt vmcnt(0)
s_branch L_chkr0
L_giver0:
s_mov_b32 s59, 0
s_branch L_okr0
L_rtyr1:
s_sub_u32 s59, s59, 1
s_cbranch_scc1 L_giver1
s_add_u32 s52, s23, 20480
buffer_load_dwordx4 v[36:39], v12, s[16:19], s52 offen sc1
s_waitcnt vmcnt(0)
s_branch L_chkr1
L_giver1:
s_mov_b32 s59, 0
s_branch L_okr1
L_frc:
s_sub_u32 s59, s59, 1
s_cbranch_scc1 L_fgc
s_sleep 2
buffer_load_dword v2, v116, s[16:19], s97 offen sc1
s_waitcnt vmcnt(0)
s_branch L_fcc
L_fgc:
s_mov_b32 s59, 0
s_branch L_foc
L_arrive:
s_mov_b64 exec, 1
buffer_atomic_add v15, v14, s[8:11], 0 offen
s_mov_b64 exec, -1
s_branch L_arrived
L_dslow:
s_and_b32 s52, s52, 255
s_cmp_ge_u32 s52, 32
s_cbranch_scc1 L_epslow
L_dretry:
s_sub_u32 s59, s59, 1
s_cbranch_scc1 L_dgive
s_sleep 4
buffer_load_dword v2, v3, s[8:11], 0 offen sc1
s_branch L_dchk
L_dgive:
s_mov_b32 s59, 0
L_epslow:
v_pk_mul_f32 v[16:17], v[128:129], v[128:129]
v_pk_mul_f32 v[18:19], v[130:131], v[130:131]
v_pk_mul_f32 v[20:21], v[132:133], v[132:133]
v_pk_mul_f32 v[22:23], v[134:135], v[134:135]
v_pk_fma_f32 v[16:17], v[16:17], s[54:55], v[14:15]
v_pk_fma_f32 v[18:19], v[18:19], s[54:55], v[14:15]
v_pk_fma_f32 v[20:21], v[20:21], s[54:55], v[14:15]
v_pk_fma_f32 v[22:23], v[22:23], s[54:55], v[14:15]
v_pk_mul_f32 v[16:17], v[16:17], v[128:129]
v_pk_mul_f32 v[18:19], v[18:19], v[130:131]
v_pk_mul_f32 v[20:21], v[20:21], v[132:133]
v_pk_mul_f32 v[22:23], v[22:23], v[134:135]
v_exp_f32 v16, v16
v_exp_f32 v17, v17
v_pk_mul_f32 v[24:25], v[128:129], v[192:193]
v_exp_f32 v18, v18
v_exp_f32 v19, v19
v_pk_mul_f32 v[26:27], v[130:131], v[194:195]
v_exp_f32 v20, v20
v_exp_f32 v21, v21
v_pk_mul_f32 v[28:29], v[132:133], v[196:197]
v_exp_f32 v22, v22
v_exp_f32 v23, v23
v_pk_mul_f32 v[30:31], v[134:135], v[198:199]
v_pk_add_f32 v[16:17], v[16:17], 1.0 op_sel_hi:[1,0]
v_pk_add_f32 v[18:19], v[18:19], 1.0 op_sel_hi:[1,0]
v_pk_add_f32 v[20:21], v[20:21], 1.0 op_sel_hi:[1,0]
v_pk_add_f32 v[22:23], v[22:23], 1.0 op_sel_hi:[1,0]
v_rcp_f32 v16, v16
v_rcp_f32 v17, v17
v_rcp_f32 v18, v18
v_rcp_f32 v19, v19
v_rcp_f32 v20, v20
v_rcp_f32 v21, v21
v_rcp_f32 v22, v22
v_rcp_f32 v23, v23
v_pk_mul_f32 v[24:25], v[24:25], v[16:17]
v_pk_mul_f32 v[26:27], v[26:27], v[18:19]
v_pk_mul_f32 v[28:29], v[28:29], v[20:21]
v_pk_mul_f32 v[30:31], v[30:31], v[22:23]
v_cvt_pk_bf16_f32 v64, v24, v25
v_cvt_pk_bf16_f32 v65, v26, v27
v_cvt_pk_bf16_f32 v66, v28, v29
v_cvt_pk_bf16_f32 v67, v30, v31
buffer_store_dwordx4 v[64:67], v12, s[16:19], s34 offen offset:0 sc1
v_pk_mul_f32 v[32:33], v[136:137], v[136:137]
v_pk_mul_f32 v[34:35], v[138:139], v[138:139]
v_pk_mul_f32 v[36:37], v[140:141], v[140:141]
v_pk_mul_f32 v[38:39], v[142:143], v[142:143]
v_pk_fma_f32 v[32:33], v[32:33], s[54:55], v[14:15]
v_pk_fma_f32 v[34:35], v[34:35], s[54:55], v[14:15]
v_pk_fma_f32 v[36:37], v[36:37], s[54:55], v[14:15]
v_pk_fma_f32 v[38:39], v[38:39], s[54:55], v[14:15]
v_pk_mul_f32 v[32:33], v[32:33], v[136:137]
v_pk_mul_f32 v[34:35], v[34:35], v[138:139]
v_pk_mul_f32 v[36:37], v[36:37], v[140:141]
v_pk_mul_f32 v[38:39], v[38:39], v[142:143]
v_exp_f32 v32, v32
v_exp_f32 v33, v33
v_pk_mul_f32 v[40:41], v[136:137], v[200:201]
v_exp_f32 v34, v34
v_exp_f32 v35, v35
v_pk_mul_f32 v[42:43], v[138:139], v[202:203]
v_exp_f32 v36, v36
v_exp_f32 v37, v37
v_pk_mul_f32 v[44:45], v[140:141], v[204:205]
v_exp_f32 v38, v38
v_exp_f32 v39, v39
v_pk_mul_f32 v[46:47], v[142:143], v[206:207]
v_pk_add_f32 v[32:33], v[32:33], 1.0 op_sel_hi:[1,0]
v_pk_add_f32 v[34:35], v[34:35], 1.0 op_sel_hi:[1,0]
v_pk_add_f32 v[36:37], v[36:37], 1.0 op_sel_hi:[1,0]
v_pk_add_f32 v[38:39], v[38:39], 1.0 op_sel_hi:[1,0]
v_rcp_f32 v32, v32
v_rcp_f32 v33, v33
v_rcp_f32 v34, v34
v_rcp_f32 v35, v35
v_rcp_f32 v36, v36
v_rcp_f32 v37, v37
v_rcp_f32 v38, v38
v_rcp_f32 v39, v39
v_pk_mul_f32 v[40:41], v[40:41], v[32:33]
v_pk_mul_f32 v[42:43], v[42:43], v[34:35]
v_pk_mul_f32 v[44:45], v[44:45], v[36:37]
v_pk_mul_f32 v[46:47], v[46:47], v[38:39]
v_cvt_pk_bf16_f32 v68, v40, v41
v_cvt_pk_bf16_f32 v69, v42, v43
v_cvt_pk_bf16_f32 v70, v44, v45
v_cvt_pk_bf16_f32 v71, v46, v47
buffer_store_dwordx4 v[68:71], v12, s[16:19], s34 offen offset:1024 sc1
s_add_u32 s34, s34, 114688
v_pk_mul_f32 v[16:17], v[144:145], v[144:145]
v_pk_mul_f32 v[18:19], v[146:147], v[146:147]
v_pk_mul_f32 v[20:21], v[148:149], v[148:149]
v_pk_mul_f32 v[22:23], v[150:151], v[150:151]
v_pk_fma_f32 v[16:17], v[16:17], s[54:55], v[14:15]
v_pk_fma_f32 v[18:19], v[18:19], s[54:55], v[14:15]
v_pk_fma_f32 v[20:21], v[20:21], s[54:55], v[14:15]
v_pk_fma_f32 v[22:23], v[22:23], s[54:55], v[14:15]
v_pk_mul_f32 v[16:17], v[16:17], v[144:145]
v_pk_mul_f32 v[18:19], v[18:19], v[146:147]
v_pk_mul_f32 v[20:21], v[20:21], v[148:149]
v_pk_mul_f32 v[22:23], v[22:23], v[150:151]
v_exp_f32 v16, v16
v_exp_f32 v17, v17
v_pk_mul_f32 v[24:25], v[144:145], v[208:209]
v_exp_f32 v18, v18
v_exp_f32 v19, v19
v_pk_mul_f32 v[26:27], v[146:147], v[210:211]
v_exp_f32 v20, v20
v_exp_f32 v21, v21
v_pk_mul_f32 v[28:29], v[148:149], v[212:213]
v_exp_f32 v22, v22
v_exp_f32 v23, v23
v_pk_mul_f32 v[30:31], v[150:151], v[214:215]
v_pk_add_f32 v[16:17], v[16:17], 1.0 op_sel_hi:[1,0]
v_pk_add_f32 v[18:19], v[18:19], 1.0 op_sel_hi:[1,0]
v_pk_add_f32 v[20:21], v[20:21], 1.0 op_sel_hi:[1,0]
v_pk_add_f32 v[22:23], v[22:23], 1.0 op_sel_hi:[1,0]
v_rcp_f32 v16, v16
v_rcp_f32 v17, v17
v_rcp_f32 v18, v18
v_rcp_f32 v19, v19
v_rcp_f32 v20, v20
v_rcp_f32 v21, v21
v_rcp_f32 v22, v22
v_rcp_f32 v23, v23
v_pk_mul_f32 v[24:25], v[24:25], v[16:17]
v_pk_mul_f32 v[26:27], v[26:27], v[18:19]
v_pk_mul_f32 v[28:29], v[28:29], v[20:21]
v_pk_mul_f32 v[30:31], v[30:31], v[22:23]
v_cvt_pk_bf16_f32 v72, v24, v25
v_cvt_pk_bf16_f32 v73, v26, v27
v_cvt_pk_bf16_f32 v74, v28, v29
v_cvt_pk_bf16_f32 v75, v30, v31
buffer_store_dwordx4 v[72:75], v12, s[16:19], s34 offen offset:0 sc1
v_pk_mul_f32 v[32:33], v[152:153], v[152:153]
v_pk_mul_f32 v[34:35], v[154:155], v[154:155]
v_pk_mul_f32 v[36:37], v[156:157], v[156:157]
v_pk_mul_f32 v[38:39], v[158:159], v[158:159]
v_pk_fma_f32 v[32:33], v[32:33], s[54:55], v[14:15]
v_pk_fma_f32 v[34:35], v[34:35], s[54:55], v[14:15]
v_pk_fma_f32 v[36:37], v[36:37], s[54:55], v[14:15]
v_pk_fma_f32 v[38:39], v[38:39], s[54:55], v[14:15]
v_pk_mul_f32 v[32:33], v[32:33], v[152:153]
v_pk_mul_f32 v[34:35], v[34:35], v[154:155]
v_pk_mul_f32 v[36:37], v[36:37], v[156:157]
v_pk_mul_f32 v[38:39], v[38:39], v[158:159]
v_exp_f32 v32, v32
v_exp_f32 v33, v33
v_pk_mul_f32 v[40:41], v[152:153], v[216:217]
v_exp_f32 v34, v34
v_exp_f32 v35, v35
v_pk_mul_f32 v[42:43], v[154:155], v[218:219]
v_exp_f32 v36, v36
v_exp_f32 v37, v37
v_pk_mul_f32 v[44:45], v[156:157], v[220:221]
v_exp_f32 v38, v38
v_exp_f32 v39, v39
v_pk_mul_f32 v[46:47], v[158:159], v[222:223]
v_pk_add_f32 v[32:33], v[32:33], 1.0 op_sel_hi:[1,0]
v_pk_add_f32 v[34:35], v[34:35], 1.0 op_sel_hi:[1,0]
v_pk_add_f32 v[36:37], v[36:37], 1.0 op_sel_hi:[1,0]
v_pk_add_f32 v[38:39], v[38:39], 1.0 op_sel_hi:[1,0]
v_rcp_f32 v32, v32
v_rcp_f32 v33, v33
v_rcp_f32 v34, v34
v_rcp_f32 v35, v35
v_rcp_f32 v36, v36
v_rcp_f32 v37, v37
v_rcp_f32 v38, v38
v_rcp_f32 v39, v39
v_pk_mul_f32 v[40:41], v[40:41], v[32:33]
v_pk_mul_f32 v[42:43], v[42:43], v[34:35]
v_pk_mul_f32 v[44:45], v[44:45], v[36:37]
v_pk_mul_f32 v[46:47], v[46:47], v[38:39]
v_cvt_pk_bf16_f32 v76, v40, v41
v_cvt_pk_bf16_f32 v77, v42, v43
v_cvt_pk_bf16_f32 v78, v44, v45
v_cvt_pk_bf16_f32 v79, v46, v47
s_waitcnt vmcnt(1)
buffer_store_dword v112, v1, s[16:19], s96 offen sc1
buffer_store_dwordx4 v[76:79], v12, s[16:19], s34 offen offset:1024 sc1
s_add_u32 s34, s34, 114688
v_pk_mul_f32 v[16:17], v[160:161], v[160:161]
v_pk_mul_f32 v[18:19], v[162:163], v[162:163]
v_pk_mul_f32 v[20:21], v[164:165], v[164:165]
v_pk_mul_f32 v[22:23], v[166:167], v[166:167]
v_pk_fma_f32 v[16:17], v[16:17], s[54:55], v[14:15]
v_pk_fma_f32 v[18:19], v[18:19], s[54:55], v[14:15]
v_pk_fma_f32 v[20:21], v[20:21], s[54:55], v[14:15]
v_pk_fma_f32 v[22:23], v[22:23], s[54:55], v[14:15]
v_pk_mul_f32 v[16:17], v[16:17], v[160:161]
v_pk_mul_f32 v[18:19], v[18:19], v[162:163]
v_pk_mul_f32 v[20:21], v[20:21], v[164:165]
v_pk_mul_f32 v[22:23], v[22:23], v[166:167]
v_exp_f32 v16, v16
v_exp_f32 v17, v17
v_pk_mul_f32 v[24:25], v[160:161], v[224:225]
v_exp_f32 v18, v18
v_exp_f32 v19, v19
v_pk_mul_f32 v[26:27], v[162:163], v[226:227]
v_exp_f32 v20, v20
v_exp_f32 v21, v21
v_pk_mul_f32 v[28:29], v[164:165], v[228:229]
v_exp_f32 v22, v22
v_exp_f32 v23, v23
v_pk_mul_f32 v[30:31], v[166:167], v[230:231]
v_pk_add_f32 v[16:17], v[16:17], 1.0 op_sel_hi:[1,0]
v_pk_add_f32 v[18:19], v[18:19], 1.0 op_sel_hi:[1,0]
v_pk_add_f32 v[20:21], v[20:21], 1.0 op_sel_hi:[1,0]
v_pk_add_f32 v[22:23], v[22:23], 1.0 op_sel_hi:[1,0]
v_rcp_f32 v16, v16
v_rcp_f32 v17, v17
v_rcp_f32 v18, v18
v_rcp_f32 v19, v19
v_rcp_f32 v20, v20
v_rcp_f32 v21, v21
v_rcp_f32 v22, v22
v_rcp_f32 v23, v23
v_pk_mul_f32 v[24:25], v[24:25], v[16:17]
v_pk_mul_f32 v[26:27], v[26:27], v[18:19]
v_pk_mul_f32 v[28:29], v[28:29], v[20:21]
v_pk_mul_f32 v[30:31], v[30:31], v[22:23]
v_cvt_pk_bf16_f32 v80, v24, v25
v_cvt_pk_bf16_f32 v81, v26, v27
v_cvt_pk_bf16_f32 v82, v28, v29
v_cvt_pk_bf16_f32 v83, v30, v31
buffer_store_dwordx4 v[80:83], v12, s[16:19], s34 offen offset:0 sc1
v_pk_mul_f32 v[32:33], v[168:169], v[168:169]
v_pk_mul_f32 v[34:35], v[170:171], v[170:171]
v_pk_mul_f32 v[36:37], v[172:173], v[172:173]
v_pk_mul_f32 v[38:39], v[174:175], v[174:175]
v_pk_fma_f32 v[32:33], v[32:33], s[54:55], v[14:15]
v_pk_fma_f32 v[34:35], v[34:35], s[54:55], v[14:15]
v_pk_fma_f32 v[36:37], v[36:37], s[54:55], v[14:15]
v_pk_fma_f32 v[38:39], v[38:39], s[54:55], v[14:15]
v_pk_mul_f32 v[32:33], v[32:33], v[168:169]
v_pk_mul_f32 v[34:35], v[34:35], v[170:171]
v_pk_mul_f32 v[36:37], v[36:37], v[172:173]
v_pk_mul_f32 v[38:39], v[38:39], v[174:175]
v_exp_f32 v32, v32
v_exp_f32 v33, v33
v_pk_mul_f32 v[40:41], v[168:169], v[232:233]
v_exp_f32 v34, v34
v_exp_f32 v35, v35
v_pk_mul_f32 v[42:43], v[170:171], v[234:235]
v_exp_f32 v36, v36
v_exp_f32 v37, v37
v_pk_mul_f32 v[44:45], v[172:173], v[236:237]
v_exp_f32 v38, v38
v_exp_f32 v39, v39
v_pk_mul_f32 v[46:47], v[174:175], v[238:239]
v_pk_add_f32 v[32:33], v[32:33], 1.0 op_sel_hi:[1,0]
v_pk_add_f32 v[34:35], v[34:35], 1.0 op_sel_hi:[1,0]
v_pk_add_f32 v[36:37], v[36:37], 1.0 op_sel_hi:[1,0]
v_pk_add_f32 v[38:39], v[38:39], 1.0 op_sel_hi:[1,0]
v_rcp_f32 v32, v32
v_rcp_f32 v33, v33
v_rcp_f32 v34, v34
v_rcp_f32 v35, v35
v_rcp_f32 v36, v36
v_rcp_f32 v37, v37
v_rcp_f32 v38, v38
v_rcp_f32 v39, v39
v_pk_mul_f32 v[40:41], v[40:41], v[32:33]
v_pk_mul_f32 v[42:43], v[42:43], v[34:35]
v_pk_mul_f32 v[44:45], v[44:45], v[36:37]
v_pk_mul_f32 v[46:47], v[46:47], v[38:39]
v_cvt_pk_bf16_f32 v84, v40, v41
v_cvt_pk_bf16_f32 v85, v42, v43
v_cvt_pk_bf16_f32 v86, v44, v45
v_cvt_pk_bf16_f32 v87, v46, v47
s_waitcnt vmcnt(1)
buffer_store_dword v113, v1, s[16:19], s96 offen sc1
buffer_store_dwordx4 v[84:87], v12, s[16:19], s34 offen offset:1024 sc1
s_add_u32 s34, s34, 114688
buffer_load_dword v2, v116, s[16:19], s97 offen sc1
v_pk_mul_f32 v[16:17], v[176:177], v[176:177]
v_pk_mul_f32 v[18:19], v[178:179], v[178:179]
v_pk_mul_f32 v[20:21], v[180:181], v[180:181]
v_pk_mul_f32 v[22:23], v[182:183], v[182:183]
v_pk_fma_f32 v[16:17], v[16:17], s[54:55], v[14:15]
v_pk_fma_f32 v[18:19], v[18:19], s[54:55], v[14:15]
v_pk_fma_f32 v[20:21], v[20:21], s[54:55], v[14:15]
v_pk_fma_f32 v[22:23], v[22:23], s[54:55], v[14:15]
v_pk_mul_f32 v[16:17], v[16:17], v[176:177]
v_pk_mul_f32 v[18:19], v[18:19], v[178:179]
v_pk_mul_f32 v[20:21], v[20:21], v[180:181]
v_pk_mul_f32 v[22:23], v[22:23], v[182:183]
v_exp_f32 v16, v16
v_exp_f32 v17, v17
v_pk_mul_f32 v[24:25], v[176:177], v[240:241]
v_exp_f32 v18, v18
v_exp_f32 v19, v19
v_pk_mul_f32 v[26:27], v[178:179], v[242:243]
v_exp_f32 v20, v20
v_exp_f32 v21, v21
v_pk_mul_f32 v[28:29], v[180:181], v[244:245]
v_exp_f32 v22, v22
v_exp_f32 v23, v23
v_pk_mul_f32 v[30:31], v[182:183], v[246:247]
v_pk_add_f32 v[16:17], v[16:17], 1.0 op_sel_hi:[1,0]
v_pk_add_f32 v[18:19], v[18:19], 1.0 op_sel_hi:[1,0]
v_pk_add_f32 v[20:21], v[20:21], 1.0 op_sel_hi:[1,0]
v_pk_add_f32 v[22:23], v[22:23], 1.0 op_sel_hi:[1,0]
v_rcp_f32 v16, v16
v_rcp_f32 v17, v17
v_rcp_f32 v18, v18
v_rcp_f32 v19, v19
v_rcp_f32 v20, v20
v_rcp_f32 v21, v21
v_rcp_f32 v22, v22
v_rcp_f32 v23, v23
v_pk_mul_f32 v[24:25], v[24:25], v[16:17]
v_pk_mul_f32 v[26:27], v[26:27], v[18:19]
v_pk_mul_f32 v[28:29], v[28:29], v[20:21]
v_pk_mul_f32 v[30:31], v[30:31], v[22:23]
v_cvt_pk_bf16_f32 v88, v24, v25
v_cvt_pk_bf16_f32 v89, v26, v27
v_cvt_pk_bf16_f32 v90, v28, v29
v_cvt_pk_bf16_f32 v91, v30, v31
buffer_store_dwordx4 v[88:91], v12, s[16:19], s34 offen offset:0 sc1
v_pk_mul_f32 v[32:33], v[184:185], v[184:185]
v_pk_mul_f32 v[34:35], v[186:187], v[186:187]
v_pk_mul_f32 v[36:37], v[188:189], v[188:189]
v_pk_mul_f32 v[38:39], v[190:191], v[190:191]
v_pk_fma_f32 v[32:33], v[32:33], s[54:55], v[14:15]
v_pk_fma_f32 v[34:35], v[34:35], s[54:55], v[14:15]
v_pk_fma_f32 v[36:37], v[36:37], s[54:55], v[14:15]
v_pk_fma_f32 v[38:39], v[38:39], s[54:55], v[14:15]
v_pk_mul_f32 v[32:33], v[32:33], v[184:185]
v_pk_mul_f32 v[34:35], v[34:35], v[186:187]
v_pk_mul_f32 v[36:37], v[36:37], v[188:189]
v_pk_mul_f32 v[38:39], v[38:39], v[190:191]
v_exp_f32 v32, v32
v_exp_f32 v33, v33
v_pk_mul_f32 v[40:41], v[184:185], v[248:249]
v_exp_f32 v34, v34
v_exp_f32 v35, v35
v_pk_mul_f32 v[42:43], v[186:187], v[250:251]
v_exp_f32 v36, v36
v_exp_f32 v37, v37
v_pk_mul_f32 v[44:45], v[188:189], v[252:253]
v_exp_f32 v38, v38
v_exp_f32 v39, v39
v_pk_mul_f32 v[46:47], v[190:191], v[254:255]
v_pk_add_f32 v[32:33], v[32:33], 1.0 op_sel_hi:[1,0]
v_pk_add_f32 v[34:35], v[34:35], 1.0 op_sel_hi:[1,0]
v_pk_add_f32 v[36:37], v[36:37], 1.0 op_sel_hi:[1,0]
v_pk_add_f32 v[38:39], v[38:39], 1.0 op_sel_hi:[1,0]
v_rcp_f32 v32, v32
v_rcp_f32 v33, v33
v_rcp_f32 v34, v34
v_rcp_f32 v35, v35
v_rcp_f32 v36, v36
v_rcp_f32 v37, v37
v_rcp_f32 v38, v38
v_rcp_f32 v39, v39
v_pk_mul_f32 v[40:41], v[40:41], v[32:33]
v_pk_mul_f32 v[42:43], v[42:43], v[34:35]
v_pk_mul_f32 v[44:45], v[44:45], v[36:37]
v_pk_mul_f32 v[46:47], v[46:47], v[38:39]
v_cvt_pk_bf16_f32 v92, v40, v41
v_cvt_pk_bf16_f32 v93, v42, v43
v_cvt_pk_bf16_f32 v94, v44, v45
v_cvt_pk_bf16_f32 v95, v46, v47
buffer_store_dwordx4 v[92:95], v12, s[16:19], s34 offen offset:1024 sc1
s_add_u32 s34, s34, 114688
s_waitcnt vmcnt(2)
v_cmp_gt_u32 vcc, 1, v2
s_and_b32 s50, vcc_lo, 0x3fff3fff
s_cbranch_scc1 L_nes
s_add_u32 m0, s37, 0
s_add_u32 s52, s36, 0
buffer_load_dwordx4 v12, s[16:19], s52 offen offset:0 sc1 lds
buffer_load_dwordx4 v12, s[16:19], s52 offen offset:1024 sc1 lds
buffer_load_dwordx4 v12, s[16:19], s52 offen offset:2048 sc1 lds
buffer_load_dwordx4 v12, s[16:19], s52 offen offset:3072 sc1 lds
s_add_u32 m0, s37, 4096
s_add_u32 s52, s36, 4096
buffer_load_dwordx4 v12, s[16:19], s52 offen offset:0 sc1 lds
buffer_load_dwordx4 v12, s[16:19], s52 offen offset:1024 sc1 lds
buffer_load_dwordx4 v12, s[16:19], s52 offen offset:2048 sc1 lds
s_add_u32 m0, s38, 0
s_add_u32 s52, s36, 458752
buffer_load_dwordx4 v12, s[16:19], s52 offen offset:0 sc1 lds
buffer_load_dwordx4 v12, s[16:19], s52 offen offset:1024 sc1 lds
buffer_load_dwordx4 v12, s[16:19], s52 offen offset:2048 sc1 lds
buffer_load_dwordx4 v12, s[16:19], s52 offen offset:3072 sc1 lds
s_add_u32 m0, s38, 4096
s_add_u32 s52, s36, 462848
buffer_load_dwordx4 v12, s[16:19], s52 offen offset:0 sc1 lds
buffer_load_dwordx4 v12, s[16:19], s52 offen offset:1024 sc1 lds
buffer_load_dwordx4 v12, s[16:19], s52 offen offset:2048 sc1 lds
s_waitcnt vmcnt(14)
buffer_store_dword v114, v1, s[16:19], s96 offen sc1
s_waitcnt vmcnt(8)
s_branch L_g2h
L_nes:
buffer_load_dword v2, v116, s[16:19], s97 offen sc1
s_waitcnt vmcnt(1)
buffer_store_dword v114, v1, s[16:19], s96 offen sc1
s_branch L_late
L_cidle:
s_barrier
v_mov_b32 v112, 0
v_mov_b32 v108, -1
v_mov_b32 v113, 0
v_mov_b32 v109, -1
v_mov_b32 v114, 0
v_mov_b32 v110, -1
v_mov_b32 v115, 0
v_mov_b32 v111, -1
s_sub_u32 s50, s30, 28
s_lshl_b32 s50, s50, 3
s_add_u32 s50, s50, s29
s_lshl_b32 s50, s50, 2
s_add_u32 s50, s50, s28
s_lshl_b32 s52, s50, 10
s_add_u32 s52, s52, 25231360
buffer_store_dwordx4 v[112:115], v12, s[16:19], s52 offen sc1
buffer_store_dword v112, v116, s[16:19], s97 offen sc1
s_cmp_lg_u32 s28, 0
s_cbranch_scc1 L_cidle2
s_sub_u32 s52, 31, s30
s_lshl_b32 s52, s52, 9
s_sub_u32 s52, s97, s52
buffer_store_dword v112, v116, s[16:19], s52 offen sc1
s_mov_b64 exec, 1
buffer_atomic_add v15, v14, s[8:11], 0 offen
s_mov_b64 exec, -1
L_cidle2:
s_mul_i32 s50, s50, 49152
s_add_u32 s52, s50, 8396800
buffer_store_dwordx4 v[108:111], v12, s[16:19], s52 offen offset:0 sc1
buffer_store_dwordx4 v[108:111], v12, s[16:19], s52 offen offset:1024 sc1
buffer_store_dwordx4 v[108:111], v12, s[16:19], s52 offen offset:2048 sc1
buffer_store_dwordx4 v[108:111], v12, s[16:19], s52 offen offset:3072 sc1
s_add_u32 s52, s50, 8400896
buffer_store_dwordx4 v[108:111], v12, s[16:19], s52 offen offset:0 sc1
buffer_store_dwordx4 v[108:111], v12, s[16:19], s52 offen offset:1024 sc1
buffer_store_dwordx4 v[108:111], v12, s[16:19], s52 offen offset:2048 sc1
buffer_store_dwordx4 v[108:111], v12, s[16:19], s52 offen offset:3072 sc1
s_add_u32 s52, s50, 8404992
buffer_store_dwordx4 v[108:111], v12, s[16:19], s52 offen offset:0 sc1
buffer_store_dwordx4 v[108:111], v12, s[16:19], s52 offen offset:1024 sc1
buffer_store_dwordx4 v[108:111], v12, s[16:19], s52 offen offset:2048 sc1
buffer_store_dwordx4 v[108:111], v12, s[16:19], s52 offen offset:3072 sc1
s_add_u32 s52, s50, 8409088
buffer_store_dwordx4 v[108:111], v12, s[16:19], s52 offen offset:0 sc1
buffer_store_dwordx4 v[108:111], v12, s[16:19], s52 offen offset:1024 sc1
buffer_store_dwordx4 v[108:111], v12, s[16:19], s52 offen offset:2048 sc1
buffer_store_dwordx4 v[108:111], v12, s[16:19], s52 offen offset:3072 sc1
s_add_u32 s52, s50, 8421376
buffer_store_dwordx4 v[108:111], v12, s[16:19], s52 offen offset:0 sc1
buffer_store_dwordx4 v[108:111], v12, s[16:19], s52 offen offset:1024 sc1
buffer_store_dwordx4 v[108:111], v12, s[16:19], s52 offen offset:2048 sc1
buffer_store_dwordx4 v[108:111], v12, s[16:19], s52 offen offset:3072 sc1
s_add_u32 s52, s50, 8425472
buffer_store_dwordx4 v[108:111], v12, s[16:19], s52 offen offset:0 sc1
buffer_store_dwordx4 v[108:111], v12, s[16:19], s52 offen offset:1024 sc1
buffer_store_dwordx4 v[108:111], v12, s[16:19], s52 offen offset:2048 sc1
buffer_store_dwordx4 v[108:111], v12, s[16:19], s52 offen offset:3072 sc1
s_add_u32 s52, s50, 8429568
buffer_store_dwordx4 v[108:111], v12, s[16:19], s52 offen offset:0 sc1
buffer_store_dwordx4 v[108:111], v12, s[16:19], s52 offen offset:1024 sc1
buffer_store_dwordx4 v[108:111], v12, s[16:19], s52 offen offset:2048 sc1
buffer_store_dwordx4 v[108:111], v12, s[16:19], s52 offen offset:3072 sc1
s_add_u32 s52, s50, 8433664
buffer_store_dwordx4 v[108:111], v12, s[16:19], s52 offen offset:0 sc1
buffer_store_dwordx4 v[108:111], v12, s[16:19], s52 offen offset:1024 sc1
buffer_store_dwordx4 v[108:111], v12, s[16:19], s52 offen offset:2048 sc1
buffer_store_dwordx4 v[108:111], v12, s[16:19], s52 offen offset:3072 sc1
s_add_u32 s52, s29, 2
s_and_b32 s52, s52, 3
s_lshl_b32 s52, s52, 2
s_add_u32 s52, s52, s30
s_sub_u32 s52, s52, 28
s_lshl_b32 s52, s52, 2
s_add_u32 s52, s52, s28
s_mul_i32 s52, s52, 114688
s_mul_i32 s53, s25, 1792
s_add_u32 s52, s52, s53
v_and_b32 v5, 15, v0
v_min_u32 v5, 13, v5
v_lshlrev_b32 v5, 7, v5
v_lshrrev_b32 v6, 4, v0
v_mul_u32_u24 v6, 7168, v6
v_add_u32 v5, v5, v6
buffer_load_dword v24, v5, s[84:87], s52 offen
buffer_load_dword v25, v5, s[12:15], s52 offen
s_add_u32 s52, s52, 28672
buffer_load_dword v26, v5, s[84:87], s52 offen
buffer_load_dword v27, v5, s[12:15], s52 offen
s_add_u32 s52, s52, 28672
buffer_load_dword v28, v5, s[84:87], s52 offen
buffer_load_dword v29, v5, s[12:15], s52 offen
s_add_u32 s52, s52, 28672
buffer_load_dword v30, v5, s[84:87], s52 offen
buffer_load_dword v31, v5, s[12:15], s52 offen
s_add_u32 s52, s52, 28672
s_waitcnt vmcnt(8)
v_mov_b32 v7, 0x80
v_mov_b32 v15, 1
v_mov_b32 v2, 0
s_mov_b64 exec, 1
buffer_atomic_add v15, v7, s[8:11], 0 offen
s_mov_b64 exec, -1
s_barrier
s_sub_u32 s52, s30, 28
s_lshl_b32 s52, s52, 2
s_add_u32 s52, s52, s28
s_lshl_b32 s52, s52, 1
s_and_b32 s53, s28, 1
s_sub_u32 s52, s52, s53
s_mul_i32 s52, s52, 114688
s_add_u32 s52, s52, s100
s_sub_u32 s52, s52, 2752512
v_lshlrev_b32 v5, 7, v0
v_lshrrev_b32 v6, 5, v0
v_mul_u32_u24 v6, 200704, v6
v_add_u32 v6, v6, v5
buffer_load_dword v16, v5, s[16:19], s52 offen sc1
s_add_u32 s52, s52, 8192
buffer_load_dword v17, v5, s[16:19], s52 offen sc1
s_add_u32 s52, s52, 8192
buffer_load_dword v18, v5, s[16:19], s52 offen sc1
s_add_u32 s52, s52, 8192
buffer_load_dword v19, v6, s[16:19], s52 offen sc1
s_add_u32 s52, s52, 208896
s_branch L_late
L_end:
s_endpgm
.section .rodata,"a"
.p2align 6
.amdhsa_kernel standalone__geglu_ffn__sampling_kernel
  .amdhsa_next_free_vgpr 256
  .amdhsa_next_free_sgpr 102
  .amdhsa_accum_offset 256
  .amdhsa_group_segment_fixed_size 0
  .amdhsa_kernarg_size 56
  .amdhsa_user_sgpr_count 2
  .amdhsa_user_sgpr_kernarg_segment_ptr 1
  .amdhsa_system_sgpr_workgroup_id_x 1
.end_amdhsa_kernel
```
